```python
import torch

def _softmax(x, axis=-1):
    return torch.softmax(x, dim=axis)
def _gelu(x):
    return torch.nn.functional.gelu(x, approximate="tanh")
def _silu(x):
    return torch.nn.functional.silu(x)
def _sigmoid(x):
    return torch.sigmoid(x)
def _layernorm(x, axis=-1, eps=1e-5):
    m = x.mean(dim=axis, keepdim=True)
    v = x.var(dim=axis, keepdim=True, unbiased=False)
    return (x - m) / torch.sqrt(v + eps)
def _scatter_add(tgt, idx, src, axis=0):
    return tgt.clone().index_add_(axis, idx, src)
def _segment_sum(src, seg, n):
    out = torch.zeros((n,) + src.shape[1:], dtype=src.dtype)
    return out.index_add_(0, seg, src)
def _pad(x, pw):
    flat = tuple(v for pair in reversed(pw) for v in pair)
    return torch.nn.functional.pad(x, flat)

kernel_name = 'sequential_preLN__mha_block_cached__dense_activation_gelu__decode'

def setup_inputs():

    _w = (lambda a: (lambda t: t.to(torch.bfloat16) if t.is_floating_point() else t)(torch.as_tensor(a)))
    def _A_setup():
        B, Sq, D = 2, 1, 512
        H, Sk, Dh = 32, 4096, 128
        return {
            "x": _w((lambda *s: torch.randn(*s, dtype=torch.bfloat16) * 0.1)(B, Sq, D)),
            "k_cache": _w((lambda *s: torch.randn(*s, dtype=torch.bfloat16) * 1.6)(B, H, Sk, Dh)),
            "v_cache": _w((lambda *s: torch.randn(*s, dtype=torch.bfloat16) * 1.6)(B, H, Sk, Dh)),
            "wq": _w((lambda *s: torch.randn(*s, dtype=torch.bfloat16) * 1.6)(D, H * Dh) * (D ** -0.5)),
            "wo": _w((lambda *s: torch.randn(*s, dtype=torch.bfloat16) * 1.6)(H * Dh, D) * ((H * Dh) ** -0.5)),
        }
    _A_in = _A_setup()

    def _B_setup():
        B, S, D, F = 2, 1, 512, 1376
        return {
            "x": _w((lambda *s: torch.randn(*s, dtype=torch.bfloat16) * 0.1)(B, S, D)),
            "w1": _w((lambda *s: torch.randn(*s, dtype=torch.bfloat16) * 3.2)(D, F) * (D ** -0.5)),
            "b1": _w((lambda *s: torch.randn(*s, dtype=torch.bfloat16) * 3.2)(F) * 0.01),
            "w2": _w((lambda *s: torch.randn(*s, dtype=torch.bfloat16) * 3.2)(F, D) * (F ** -0.5)),
            "b2": _w((lambda *s: torch.randn(*s, dtype=torch.bfloat16) * 3.2)(D) * 0.01),
        }
    _B_in = _B_setup()

    return {
        "A_x": _A_in["x"],
        "A_k_cache": _A_in["k_cache"],
        "A_v_cache": _A_in["v_cache"],
        "A_wq": _A_in["wq"],
        "A_wo": _A_in["wo"],
        "B_x": _B_in["x"],
        "B_w1": _B_in["w1"],
        "B_b1": _B_in["b1"],
        "B_w2": _B_in["w2"],
        "B_b2": _B_in["b2"],
    }

def reference(A_x, A_k_cache, A_v_cache, A_wq, A_wo, B_x, B_w1, B_b1, B_w2, B_b2):
    def _A_ref(x, k_cache, v_cache, wq, wo):
        B, Sq, D = x.shape
        H, Dh = 32, 128
        q = (lambda x, *d: x.permute(*d))((x @ wq).reshape(B, Sq, H, Dh), 0, 2, 1, 3)
        scores = torch.einsum("bhqd,bhkd->bhqk", q, k_cache) * (Dh ** -0.5)
        p = _softmax(scores, axis=-1)
        o = torch.einsum("bhqk,bhkd->bhqd", p, v_cache)
        return (lambda x, *d: x.permute(*d))(o, 0, 2, 1, 3).reshape(B, Sq, H * Dh) @ wo

    def _B_ref(x, w1, b1, w2, b2):
        h = torch.einsum("bsd,df->bsf", x, w1) + b1
        h = _gelu(h)
        return torch.einsum("bsf,fd->bsd", h, w2) + b2

    x = A_x
    h = x + _A_ref(_layernorm(x, axis=-1), A_k_cache, A_v_cache, A_wq, A_wo)
    h2 = h + _B_ref(_layernorm(h, axis=-1), B_w1, B_b1, B_w2, B_b2)
    return h2
```

```asm
; @launch grid=(256,1,1) block=(512,1,1) lds=141312
.amdgcn_target "amdgcn-amd-amdhsa--gfx950"
.text
.globl sequential_preLN__mha_block_cached__dense_activation_gelu__decode_kernel
.p2align 8
.type sequential_preLN__mha_block_cached__dense_activation_gelu__decode_kernel,@function
sequential_preLN__mha_block_cached__dense_activation_gelu__decode_kernel:
    s_cmp_ge_u32 s2, 256
    s_cbranch_scc1 L_end
    s_load_dwordx16 s[16:31], s[0:1], 0
    s_load_dwordx8 s[32:39], s[0:1], 64
    s_load_dwordx2 s[40:41], s[0:1], 96
    v_and_b32 v1, 63, v0
    v_lshrrev_b32 v26, 6, v0
    v_lshlrev_b32 v6, 4, v1
    v_readfirstlane_b32 s3, v26
    v_mov_b32 v32, 0
    v_mov_b32 v33, 0
    v_mov_b32 v34, 0
    v_mov_b32 v35, 0
    ds_write_b128 v32, v[32:35] offset:14976
    ds_write_b32 v32, v32 offset:14992
    s_cmp_lt_u32 s3, 4
    s_cbranch_scc1 L_nopf_1
    s_getpc_b64 s[60:61]
L_pcref:
    s_sub_u32 s60, s60, L_pcref-sequential_preLN__mha_block_cached__dense_activation_gelu__decode_kernel
    s_subb_u32 s61, s61, 0
    s_and_b32 s61, s61, 0xffff
    s_mov_b32 s62, L_codeend-sequential_preLN__mha_block_cached__dense_activation_gelu__decode_kernel
    s_mov_b32 s63, 0x20000
    s_sub_u32 s7, s3, 4
    s_lshl_b32 s7, s7, 12
    buffer_load_dwordx4 v[64:67], v6, s[60:63], s7 offen offset:0
    buffer_load_dwordx4 v[68:71], v6, s[60:63], s7 offen offset:1024
    buffer_load_dwordx4 v[72:75], v6, s[60:63], s7 offen offset:2048
    buffer_load_dwordx4 v[76:79], v6, s[60:63], s7 offen offset:3072
L_nopf_1:
    v_and_b32 v27, 8, v0
    v_lshlrev_b32 v27, 8, v27
    v_add_u32 v4, v6, v27
    v_sub_u32 v5, v6, v27
    v_add_u32 v5, 0x800, v5
    v_and_b32 v2, 15, v0
    v_bfe_u32 v3, v0, 4, 2
    s_lshr_b32 s4, s2, 3
    s_and_b32 s5, s2, 7
    s_cmp_lt_u32 s5, 5
    s_cselect_b32 s101, 1, 0
    s_andn2_b32 s101, s101, s5
    s_sub_u32 s95, s5, 1
    s_cmp_gt_u32 s5, 2
    s_subb_u32 s95, s95, 0
    s_cmp_gt_u32 s5, 4
    s_subb_u32 s95, s95, 0
    s_mul_i32 s95, s95, 22
    s_lshl_b32 s8, s5, 2
    s_add_u32 s8, s8, 111
    s_cmp_eq_u32 s101, 1
    s_cselect_b32 s95, s8, s95
    s_cselect_b32 s43, -1, 21
    s_mul_i32 s7, s4, 8
    s_add_u32 s95, s95, s7
    s_add_u32 s43, s43, s95
    s_lshl_b32 s100, s4, 20
    s_and_b32 s7, s4, 1
    s_lshl_b32 s7, s7, 25
    s_add_u32 s100, s100, s7
    s_lshl_b32 s95, s95, 12
    s_lshl_b32 s43, s43, 12
    s_and_b32 s43, s43, 0xfffff
    s_add_u32 s43, s43, s100
    v_cmp_eq_u32 vcc, 0, v1
    v_mov_b32 v31, 0x10000000
    s_sub_u32 s7, s3, 1
    s_lshl_b32 s7, s7, 12
    s_add_u32 s10, s95, s7
    s_and_b32 s11, s10, 0xfffff
    s_add_u32 s11, s11, s100
    v_cndmask_b32 v7, v31, 0, vcc
    s_waitcnt lgkmcnt(0)
    s_mov_b32 s44, s18
    s_and_b32 s45, s19, 0xffff
    s_mov_b32 s46, 0x4000000
    s_mov_b32 s47, 0x20000
    s_mov_b32 s48, s20
    s_and_b32 s49, s21, 0xffff
    s_mov_b32 s50, 0x4000000
    s_mov_b32 s51, 0x20000
    s_mov_b32 s52, s40
    s_and_b32 s53, s41, 0xffff
    s_mov_b32 s54, 0x10000000
    s_mov_b32 s55, 0x20000
    s_mov_b32 s64, s38
    s_and_b32 s65, s39, 0xffff
    s_mov_b32 s66, 0x100
    s_mov_b32 s67, 0x20000
    s_cmp_eq_u32 s3, 0
    s_cbranch_scc1 L_qpath_2
    s_cmp_lg_u32 s5, 4
    s_cbranch_scc1 L_skipclr_6
    s_cmp_lg_u32 s3, 1
    s_cbranch_scc1 L_skipclr_6
    v_mov_b32 v34, -1
    v_mov_b32 v35, -1
    v_mov_b32 v36, -1
    v_mov_b32 v37, -1
    v_mov_b32 v38, 0
    v_mov_b32 v39, 1
    s_mul_i32 s7, s4, 6144
    s_add_u32 s8, s7, 4096
    buffer_store_dwordx4 v[34:37], v6, s[52:55], s7 offen offset:0 sc1
    buffer_store_dwordx4 v[34:37], v6, s[52:55], s7 offen offset:1024 sc1
    buffer_store_dwordx4 v[34:37], v6, s[52:55], s7 offen offset:2048 sc1
    buffer_store_dwordx4 v[34:37], v6, s[52:55], s7 offen offset:3072 sc1
    buffer_store_dwordx4 v[34:37], v6, s[52:55], s8 offen offset:0 sc1
    buffer_store_dwordx4 v[34:37], v6, s[52:55], s8 offen offset:1024 sc1
    s_lshl_b32 s7, s4, 11
    s_add_u32 s7, s7, 0x30000
    v_lshlrev_b32 v40, 7, v1
    s_mov_b32 exec_lo, 0xffff
    s_mov_b32 exec_hi, 0x0
    buffer_store_dwordx2 v[34:35], v40, s[52:55], s7 offen sc1
    s_mov_b64 exec, -1
    s_lshl_b32 s7, s4, 8
    s_add_u32 s7, s7, 0x40000
    buffer_store_dword v38, v7, s[52:55], s7 offen sc1
    s_lshl_b32 s7, s4, 2
    s_add_u32 s7, s7, 128
    s_barrier
    s_waitcnt vmcnt(0)
    buffer_store_dword v39, v7, s[64:67], s7 offen sc1
    s_branch L_pre_7
L_skipclr_6:
    s_barrier
L_pre_7:
    s_cmp_eq_u32 s101, 1
    s_cbranch_scc1 L_setup_3
    buffer_load_dwordx4 v[128:131], v4, s[44:47], s11 offen nt
    buffer_load_dwordx4 v[132:135], v4, s[44:47], s11 offen offset:1024 nt
    buffer_load_dwordx4 v[136:139], v5, s[44:47], s11 offen nt
    buffer_load_dwordx4 v[140:143], v5, s[44:47], s11 offen offset:1024 nt
    s_barrier
    buffer_load_dwordx4 v[144:147], v6, s[48:51], s11 offen offset:0 nt
    buffer_load_dwordx4 v[148:151], v6, s[48:51], s11 offen offset:1024 nt
    buffer_load_dwordx4 v[152:155], v6, s[48:51], s11 offen offset:2048 nt
    buffer_load_dwordx4 v[156:159], v6, s[48:51], s11 offen offset:3072 nt
    s_add_u32 s10, s10, 0x7000
    s_and_b32 s11, s10, 0xfffff
    s_add_u32 s11, s11, s100
    s_waitcnt vmcnt(4)
    buffer_load_dwordx4 v[160:163], v4, s[44:47], s11 offen nt
    buffer_load_dwordx4 v[164:167], v4, s[44:47], s11 offen offset:1024 nt
    buffer_load_dwordx4 v[168:171], v5, s[44:47], s11 offen nt
    buffer_load_dwordx4 v[172:175], v5, s[44:47], s11 offen offset:1024 nt
    s_waitcnt vmcnt(4)
    buffer_load_dwordx4 v[176:179], v6, s[48:51], s11 offen offset:0 nt
    buffer_load_dwordx4 v[180:183], v6, s[48:51], s11 offen offset:1024 nt
    buffer_load_dwordx4 v[184:187], v6, s[48:51], s11 offen offset:2048 nt
    buffer_load_dwordx4 v[188:191], v6, s[48:51], s11 offen offset:3072 nt
    s_add_u32 s10, s10, 0x7000
    s_and_b32 s11, s10, 0xfffff
    s_add_u32 s11, s11, s100
    s_waitcnt vmcnt(4)
    buffer_load_dwordx4 v[192:195], v4, s[44:47], s11 offen nt
    buffer_load_dwordx4 v[196:199], v4, s[44:47], s11 offen offset:1024 nt
    buffer_load_dwordx4 v[200:203], v5, s[44:47], s11 offen nt
    buffer_load_dwordx4 v[204:207], v5, s[44:47], s11 offen offset:1024 nt
    s_waitcnt vmcnt(4)
    buffer_load_dwordx4 v[208:211], v6, s[48:51], s11 offen offset:0 nt
    buffer_load_dwordx4 v[212:215], v6, s[48:51], s11 offen offset:1024 nt
    buffer_load_dwordx4 v[216:219], v6, s[48:51], s11 offen offset:2048 nt
    buffer_load_dwordx4 v[220:223], v6, s[48:51], s11 offen offset:3072 nt
    s_branch L_setup_3
L_qpath_2:
    s_setprio 3
    s_load_dword s96, s[40:41], 0x44000
    s_mov_b32 s56, s16
    s_and_b32 s57, s17, 0xffff
    s_mov_b32 s58, 0x800
    s_mov_b32 s59, 0x20000
    s_mov_b32 s60, s22
    s_and_b32 s61, s23, 0xffff
    s_mov_b32 s62, 0x400000
    s_mov_b32 s63, 0x20000
    v_lshlrev_b32 v28, 5, v1
    buffer_load_dwordx4 v[224:227], v28, s[56:59], 0 offen
    buffer_load_dwordx4 v[228:231], v28, s[56:59], 0 offen offset:16
    v_lshl_add_u32 v29, v2, 2, v3
    v_lshlrev_b32 v29, 1, v29
    s_lshl_b32 s7, s5, 7
    buffer_load_ushort v232, v29, s[56:59], s7 offen
    buffer_load_ushort v233, v29, s[56:59], s7 offen offset:1024
    v_lshlrev_b32 v30, 13, v3
    v_lshl_add_u32 v30, v2, 4, v30
    s_lshl_b32 s7, s5, 19
    s_lshl_b32 s8, s4, 8
    s_add_u32 s7, s7, s8
    buffer_load_dwordx4 v[64:67], v30, s[60:63], s7 offen nt
    s_add_u32 s7, s7, 0x8000
    buffer_load_dwordx4 v[68:71], v30, s[60:63], s7 offen nt
    s_add_u32 s7, s7, 0x8000
    buffer_load_dwordx4 v[72:75], v30, s[60:63], s7 offen nt
    s_add_u32 s7, s7, 0x8000
    buffer_load_dwordx4 v[76:79], v30, s[60:63], s7 offen nt
    s_add_u32 s7, s7, 0x8000
    buffer_load_dwordx4 v[80:83], v30, s[60:63], s7 offen nt
    s_add_u32 s7, s7, 0x8000
    buffer_load_dwordx4 v[84:87], v30, s[60:63], s7 offen nt
    s_add_u32 s7, s7, 0x8000
    buffer_load_dwordx4 v[88:91], v30, s[60:63], s7 offen nt
    s_add_u32 s7, s7, 0x8000
    buffer_load_dwordx4 v[92:95], v30, s[60:63], s7 offen nt
    s_add_u32 s7, s7, 0x8000
    buffer_load_dwordx4 v[96:99], v30, s[60:63], s7 offen nt
    s_add_u32 s7, s7, 0x8000
    buffer_load_dwordx4 v[100:103], v30, s[60:63], s7 offen nt
    s_add_u32 s7, s7, 0x8000
    buffer_load_dwordx4 v[104:107], v30, s[60:63], s7 offen nt
    s_add_u32 s7, s7, 0x8000
    buffer_load_dwordx4 v[108:111], v30, s[60:63], s7 offen nt
    s_add_u32 s7, s7, 0x8000
    buffer_load_dwordx4 v[112:115], v30, s[60:63], s7 offen nt
    s_add_u32 s7, s7, 0x8000
    buffer_load_dwordx4 v[116:119], v30, s[60:63], s7 offen nt
    s_add_u32 s7, s7, 0x8000
    buffer_load_dwordx4 v[120:123], v30, s[60:63], s7 offen nt
    s_add_u32 s7, s7, 0x8000
    buffer_load_dwordx4 v[124:127], v30, s[60:63], s7 offen nt
    s_barrier
L_setup_3:
    s_mov_b32 s56, s16
    s_and_b32 s57, s17, 0xffff
    s_mov_b32 s58, 0x800
    s_mov_b32 s59, 0x20000
    s_lshl_b32 s7, s4, 8
    s_add_u32 s7, s7, 0x40000
    s_add_u32 s98, s40, s7
    s_addc_u32 s99, s41, 0
    s_mul_i32 s6, s4, 8
    s_add_u32 s6, s6, 134
    s_xor_b32 s12, s100, 0x2000000
    s_mov_b32 s68, 0x3db504f3
    s_mov_b32 s69, 0x3fb8aa3b
    s_mov_b32 s13, 262144
    s_and_b32 s15, s4, 15
    s_cmp_lt_u32 s4, 16
    s_cselect_b32 s14, 2, 3
    s_cmp_eq_u32 s5, 2
    s_cselect_b32 s14, s14, 0
    s_cmp_eq_u32 s5, 0
    s_cselect_b32 s14, 1, s14
    v_and_b32 v28, 1, v3
    v_cmp_eq_u32 s[74:75], 1, v28
    v_and_b32 v29, 1, v0
    v_cmp_eq_u32 s[70:71], 1, v29
    v_lshlrev_b32 v29, 4, v29
    v_mov_b32 v30, 0xffff
    v_lshlrev_b32 v30, v29, v30
    v_bfe_u32 v31, v0, 1, 2
    v_cmp_eq_u32 vcc, 0, v31
    s_nop 1
    v_cndmask_b32 v8, 0, v30, vcc
    v_cmp_eq_u32 vcc, 1, v31
    s_nop 1
    v_cndmask_b32 v9, 0, v30, vcc
    v_cmp_eq_u32 vcc, 2, v31
    s_nop 1
    v_cndmask_b32 v10, 0, v30, vcc
    v_cmp_eq_u32 vcc, 3, v31
    s_nop 1
    v_cndmask_b32 v11, 0, v30, vcc
    s_cmp_eq_u32 s3, 0
    s_cbranch_scc1 L_q2_4
    s_cmp_eq_u32 s101, 0
    s_cbranch_scc1 L_waitq_5
    s_barrier
    buffer_load_dwordx4 v[128:131], v4, s[44:47], s11 offen nt
    buffer_load_dwordx4 v[132:135], v4, s[44:47], s11 offen offset:1024 nt
    buffer_load_dwordx4 v[136:139], v5, s[44:47], s11 offen nt
    buffer_load_dwordx4 v[140:143], v5, s[44:47], s11 offen offset:1024 nt
    buffer_load_dwordx4 v[144:147], v6, s[48:51], s11 offen offset:0 nt
    buffer_load_dwordx4 v[148:151], v6, s[48:51], s11 offen offset:1024 nt
    buffer_load_dwordx4 v[152:155], v6, s[48:51], s11 offen offset:2048 nt
    buffer_load_dwordx4 v[156:159], v6, s[48:51], s11 offen offset:3072 nt
    s_cmp_eq_u32 s14, 0
    s_cbranch_scc1 L_waitq_5
    s_call_b64 s[72:73], L_prep
    s_branch L_waitq_5
L_q2_4:
    v_and_b32 v47, 31, v1
    v_lshlrev_b32 v47, 2, v47
    v_lshrrev_b32 v32, 3, v2
    v_mul_u32_u24 v32, 0x0202, v32
    v_add_u32 v32, 0x0100, v32
    v_lshl_or_b32 v32, v32, 16, v32
    v_mov_b32 v33, 0x0c0c0c0c
    v_bfi_b32 v16, v8, v32, v33
    v_bfi_b32 v17, v9, v32, v33
    v_bfi_b32 v18, v10, v32, v33
    v_bfi_b32 v19, v11, v32, v33
    s_waitcnt vmcnt(18)
    v_lshlrev_b32 v236, 16, v224
    v_and_b32 v237, 0xffff0000, v224
    v_lshlrev_b32 v238, 16, v225
    v_and_b32 v239, 0xffff0000, v225
    v_lshlrev_b32 v240, 16, v226
    v_and_b32 v241, 0xffff0000, v226
    v_lshlrev_b32 v242, 16, v227
    v_and_b32 v243, 0xffff0000, v227
    v_lshlrev_b32 v244, 16, v228
    v_and_b32 v245, 0xffff0000, v228
    v_lshlrev_b32 v246, 16, v229
    v_and_b32 v247, 0xffff0000, v229
    v_lshlrev_b32 v248, 16, v230
    v_and_b32 v249, 0xffff0000, v230
    v_lshlrev_b32 v250, 16, v231
    v_and_b32 v251, 0xffff0000, v231
    v_add_f32 v26, v236, v237
    v_add_f32 v27, v238, v239
    v_add_f32 v28, v240, v241
    v_add_f32 v29, v242, v243
    v_add_f32 v30, v244, v245
    v_add_f32 v31, v246, v247
    v_add_f32 v32, v248, v249
    v_add_f32 v33, v250, v251
    v_add_f32 v26, v26, v30
    v_add_f32 v27, v27, v31
    v_add_f32 v28, v28, v32
    v_add_f32 v29, v29, v33
    v_add_f32 v26, v26, v28
    v_add_f32 v27, v27, v29
    v_add_f32 v26, v26, v27
    s_nop 1
    v_add_f32_dpp v26, v26, v26 quad_perm:[1,0,3,2] row_mask:0xf bank_mask:0xf
    s_nop 1
    v_add_f32_dpp v26, v26, v26 quad_perm:[2,3,0,1] row_mask:0xf bank_mask:0xf
    s_nop 1
    v_add_f32_dpp v26, v26, v26 row_half_mirror row_mask:0xf bank_mask:0xf
    s_nop 1
    v_add_f32_dpp v26, v26, v26 row_mirror row_mask:0xf bank_mask:0xf
    v_mov_b32 v36, v26
    s_nop 1
    v_permlane16_swap_b32 v26, v36
    s_nop 0
    v_add_f32 v26, v26, v36
    v_mul_f32 v34, 0x3b000000, v26
    v_sub_f32 v236, v236, v34
    v_sub_f32 v237, v237, v34
    v_sub_f32 v238, v238, v34
    v_sub_f32 v239, v239, v34
    v_sub_f32 v240, v240, v34
    v_sub_f32 v241, v241, v34
    v_sub_f32 v242, v242, v34
    v_sub_f32 v243, v243, v34
    v_sub_f32 v244, v244, v34
    v_sub_f32 v245, v245, v34
    v_sub_f32 v246, v246, v34
    v_sub_f32 v247, v247, v34
    v_sub_f32 v248, v248, v34
    v_sub_f32 v249, v249, v34
    v_sub_f32 v250, v250, v34
    v_sub_f32 v251, v251, v34
    v_mul_f32 v26, v236, v236
    v_mul_f32 v27, v237, v237
    v_mul_f32 v28, v238, v238
    v_mul_f32 v29, v239, v239
    v_fmac_f32 v26, v240, v240
    v_fmac_f32 v27, v241, v241
    v_fmac_f32 v28, v242, v242
    v_fmac_f32 v29, v243, v243
    v_fmac_f32 v26, v244, v244
    v_fmac_f32 v27, v245, v245
    v_fmac_f32 v28, v246, v246
    v_fmac_f32 v29, v247, v247
    v_fmac_f32 v26, v248, v248
    v_fmac_f32 v27, v249, v249
    v_fmac_f32 v28, v250, v250
    v_fmac_f32 v29, v251, v251
    v_add_f32 v26, v26, v27
    v_add_f32 v28, v28, v29
    v_add_f32 v26, v26, v28
    s_nop 1
    v_add_f32_dpp v26, v26, v26 quad_perm:[1,0,3,2] row_mask:0xf bank_mask:0xf
    s_nop 1
    v_add_f32_dpp v26, v26, v26 quad_perm:[2,3,0,1] row_mask:0xf bank_mask:0xf
    s_nop 1
    v_add_f32_dpp v26, v26, v26 row_half_mirror row_mask:0xf bank_mask:0xf
    s_nop 1
    v_add_f32_dpp v26, v26, v26 row_mirror row_mask:0xf bank_mask:0xf
    v_mov_b32 v36, v26
    s_nop 1
    v_permlane16_swap_b32 v26, v36
    s_nop 0
    v_add_f32 v26, v26, v36
    v_mul_f32 v35, 0x3b000000, v26
    v_cvt_pk_bf16_f32 v34, v34, v34
    v_and_b32 v34, 0xffff0000, v34
    v_cvt_pk_bf16_f32 v35, v35, v35
    v_and_b32 v35, 0xffff0000, v35
    v_add_f32 v35, 0x3727c5ac, v35
    v_cvt_pk_bf16_f32 v35, v35, v35
    v_and_b32 v35, 0xffff0000, v35
    v_sqrt_f32 v35, v35
    s_nop 0
    v_cvt_pk_bf16_f32 v35, v35, v35
    v_and_b32 v35, 0xffff0000, v35
    v_mov_b32 v36, v34
    v_mov_b32 v37, v35
    s_nop 1
    v_permlane32_swap_b32 v34, v36
    v_permlane32_swap_b32 v35, v37
    s_nop 0
    v_rcp_f32 v38, v35
    v_rcp_f32 v39, v37
    s_waitcnt vmcnt(16)
    v_lshlrev_b32 v42, 16, v232
    v_sub_f32 v42, v42, v34
    v_cvt_pk_bf16_f32 v42, v42, v42
    v_and_b32 v42, 0xffff0000, v42
    v_mul_f32 v40, v42, v38
    v_fma_f32 v43, -v40, v35, v42
    v_fmac_f32 v40, v43, v38
    v_lshlrev_b32 v42, 16, v233
    v_sub_f32 v42, v42, v36
    v_cvt_pk_bf16_f32 v42, v42, v42
    v_and_b32 v42, 0xffff0000, v42
    v_mul_f32 v41, v42, v39
    v_fma_f32 v43, -v41, v37, v42
    v_fmac_f32 v41, v43, v39
    v_cvt_pk_bf16_f32 v44, v40, v41
    s_waitcnt lgkmcnt(0)
    s_add_u32 s96, s96, 1
    v_mov_b32_dpp v26, v44 row_newbcast:0 row_mask:0xf bank_mask:0xf
    v_perm_b32 v48, v26, v26, v16
    v_perm_b32 v49, v26, v26, v17
    v_perm_b32 v50, v26, v26, v18
    v_perm_b32 v51, v26, v26, v19
    s_waitcnt vmcnt(15)
    s_nop 0
    v_mfma_f32_16x16x32_bf16 v[20:23], v[64:67], v[48:51], 0
    v_mov_b32_dpp v26, v44 row_newbcast:1 row_mask:0xf bank_mask:0xf
    v_perm_b32 v52, v26, v26, v16
    v_perm_b32 v53, v26, v26, v17
    v_perm_b32 v54, v26, v26, v18
    v_perm_b32 v55, v26, v26, v19
    s_waitcnt vmcnt(14)
    s_nop 0
    v_mfma_f32_16x16x32_bf16 v[20:23], v[68:71], v[52:55], v[20:23]
    v_mov_b32_dpp v26, v44 row_newbcast:2 row_mask:0xf bank_mask:0xf
    v_perm_b32 v48, v26, v26, v16
    v_perm_b32 v49, v26, v26, v17
    v_perm_b32 v50, v26, v26, v18
    v_perm_b32 v51, v26, v26, v19
    s_waitcnt vmcnt(13)
    s_nop 0
    v_mfma_f32_16x16x32_bf16 v[20:23], v[72:75], v[48:51], v[20:23]
    v_mov_b32_dpp v26, v44 row_newbcast:3 row_mask:0xf bank_mask:0xf
    v_perm_b32 v52, v26, v26, v16
    v_perm_b32 v53, v26, v26, v17
    v_perm_b32 v54, v26, v26, v18
    v_perm_b32 v55, v26, v26, v19
    s_waitcnt vmcnt(12)
    s_nop 0
    v_mfma_f32_16x16x32_bf16 v[20:23], v[76:79], v[52:55], v[20:23]
    v_mov_b32_dpp v26, v44 row_newbcast:4 row_mask:0xf bank_mask:0xf
    v_perm_b32 v48, v26, v26, v16
    v_perm_b32 v49, v26, v26, v17
    v_perm_b32 v50, v26, v26, v18
    v_perm_b32 v51, v26, v26, v19
    s_waitcnt vmcnt(11)
    s_nop 0
    v_mfma_f32_16x16x32_bf16 v[20:23], v[80:83], v[48:51], v[20:23]
    v_mov_b32_dpp v26, v44 row_newbcast:5 row_mask:0xf bank_mask:0xf
    v_perm_b32 v52, v26, v26, v16
    v_perm_b32 v53, v26, v26, v17
    v_perm_b32 v54, v26, v26, v18
    v_perm_b32 v55, v26, v26, v19
    s_waitcnt vmcnt(10)
    s_nop 0
    v_mfma_f32_16x16x32_bf16 v[20:23], v[84:87], v[52:55], v[20:23]
    v_mov_b32_dpp v26, v44 row_newbcast:6 row_mask:0xf bank_mask:0xf
    v_perm_b32 v48, v26, v26, v16
    v_perm_b32 v49, v26, v26, v17
    v_perm_b32 v50, v26, v26, v18
    v_perm_b32 v51, v26, v26, v19
    s_waitcnt vmcnt(9)
    s_nop 0
    v_mfma_f32_16x16x32_bf16 v[20:23], v[88:91], v[48:51], v[20:23]
    v_mov_b32_dpp v26, v44 row_newbcast:7 row_mask:0xf bank_mask:0xf
    v_perm_b32 v52, v26, v26, v16
    v_perm_b32 v53, v26, v26, v17
    v_perm_b32 v54, v26, v26, v18
    v_perm_b32 v55, v26, v26, v19
    s_waitcnt vmcnt(8)
    s_nop 0
    v_mfma_f32_16x16x32_bf16 v[20:23], v[92:95], v[52:55], v[20:23]
    v_mov_b32_dpp v26, v44 row_newbcast:8 row_mask:0xf bank_mask:0xf
    v_perm_b32 v48, v26, v26, v16
    v_perm_b32 v49, v26, v26, v17
    v_perm_b32 v50, v26, v26, v18
    v_perm_b32 v51, v26, v26, v19
    s_waitcnt vmcnt(7)
    s_nop 0
    v_mfma_f32_16x16x32_bf16 v[20:23], v[96:99], v[48:51], v[20:23]
    v_mov_b32_dpp v26, v44 row_newbcast:9 row_mask:0xf bank_mask:0xf
    v_perm_b32 v52, v26, v26, v16
    v_perm_b32 v53, v26, v26, v17
    v_perm_b32 v54, v26, v26, v18
    v_perm_b32 v55, v26, v26, v19
    s_waitcnt vmcnt(6)
    s_nop 0
    v_mfma_f32_16x16x32_bf16 v[20:23], v[100:103], v[52:55], v[20:23]
    v_mov_b32_dpp v26, v44 row_newbcast:10 row_mask:0xf bank_mask:0xf
    v_perm_b32 v48, v26, v26, v16
    v_perm_b32 v49, v26, v26, v17
    v_perm_b32 v50, v26, v26, v18
    v_perm_b32 v51, v26, v26, v19
    s_waitcnt vmcnt(5)
    s_nop 0
    v_mfma_f32_16x16x32_bf16 v[20:23], v[104:107], v[48:51], v[20:23]
    v_mov_b32_dpp v26, v44 row_newbcast:11 row_mask:0xf bank_mask:0xf
    v_perm_b32 v52, v26, v26, v16
    v_perm_b32 v53, v26, v26, v17
    v_perm_b32 v54, v26, v26, v18
    v_perm_b32 v55, v26, v26, v19
    s_waitcnt vmcnt(4)
    s_nop 0
    v_mfma_f32_16x16x32_bf16 v[20:23], v[108:111], v[52:55], v[20:23]
    v_mov_b32_dpp v26, v44 row_newbcast:12 row_mask:0xf bank_mask:0xf
    v_perm_b32 v48, v26, v26, v16
    v_perm_b32 v49, v26, v26, v17
    v_perm_b32 v50, v26, v26, v18
    v_perm_b32 v51, v26, v26, v19
    s_waitcnt vmcnt(3)
    s_nop 0
    v_mfma_f32_16x16x32_bf16 v[20:23], v[112:115], v[48:51], v[20:23]
    v_mov_b32_dpp v26, v44 row_newbcast:13 row_mask:0xf bank_mask:0xf
    v_perm_b32 v52, v26, v26, v16
    v_perm_b32 v53, v26, v26, v17
    v_perm_b32 v54, v26, v26, v18
    v_perm_b32 v55, v26, v26, v19
    s_waitcnt vmcnt(2)
    s_nop 0
    v_mfma_f32_16x16x32_bf16 v[20:23], v[116:119], v[52:55], v[20:23]
    v_mov_b32_dpp v26, v44 row_newbcast:14 row_mask:0xf bank_mask:0xf
    v_perm_b32 v48, v26, v26, v16
    v_perm_b32 v49, v26, v26, v17
    v_perm_b32 v50, v26, v26, v18
    v_perm_b32 v51, v26, v26, v19
    s_waitcnt vmcnt(1)
    s_nop 0
    v_mfma_f32_16x16x32_bf16 v[20:23], v[120:123], v[48:51], v[20:23]
    v_mov_b32_dpp v26, v44 row_newbcast:15 row_mask:0xf bank_mask:0xf
    v_perm_b32 v52, v26, v26, v16
    v_perm_b32 v53, v26, v26, v17
    v_perm_b32 v54, v26, v26, v18
    v_perm_b32 v55, v26, v26, v19
    s_waitcnt vmcnt(0)
    s_nop 0
    v_mfma_f32_16x16x32_bf16 v[20:23], v[124:127], v[52:55], v[20:23]
    v_lshrrev_b32 v30, 3, v2
    v_lshlrev_b32 v30, 8, v30
    v_lshl_add_u32 v30, v3, 6, v30
    v_and_b32 v31, 7, v2
    v_lshl_add_u32 v30, v31, 1, v30
    s_lshl_b32 s7, s2, 11
    s_add_u32 s7, s7, 0x80000
    s_lshl_b32 s8, s4, 14
    s_add_u32 s8, s8, 0x80000
    v_mov_b32 v33, s96
    v_mov_b32 v35, s96
    v_mov_b32 v37, s96
    v_mov_b32 v39, s96
    v_mov_b32 v32, v20
    v_mov_b32 v34, v21
    v_mov_b32 v36, v22
    v_mov_b32 v38, v23
    buffer_store_dwordx4 v[32:35], v6, s[52:55], s7 offen sc1
    buffer_store_dwordx4 v[36:39], v6, s[52:55], s7 offen offset:1024 sc1
    v_lshlrev_b32 v45, 3, v1
    s_cmp_lg_u32 s5, 4
    s_cbranch_scc1 L_qf_8
    s_mov_b32 s9, 0x1ff
L_qp_10:
    s_bitcmp0_b32 s9, 0
    s_cbranch_scc1 L_qs_12
    s_add_u32 s11, s8, 0
    buffer_load_dwordx4 v[64:67], v6, s[52:55], s11 offen sc1
    buffer_load_dwordx4 v[68:71], v6, s[52:55], s11 offen offset:1024 sc1
L_qs_12:
    s_bitcmp0_b32 s9, 1
    s_cbranch_scc1 L_qs_13
    s_add_u32 s11, s8, 2048
    buffer_load_dwordx4 v[72:75], v6, s[52:55], s11 offen sc1
    buffer_load_dwordx4 v[76:79], v6, s[52:55], s11 offen offset:1024 sc1
L_qs_13:
    s_bitcmp0_b32 s9, 2
    s_cbranch_scc1 L_qs_14
    s_add_u32 s11, s8, 4096
    buffer_load_dwordx4 v[80:83], v6, s[52:55], s11 offen sc1
    buffer_load_dwordx4 v[84:87], v6, s[52:55], s11 offen offset:1024 sc1
L_qs_14:
    s_bitcmp0_b32 s9, 3
    s_cbranch_scc1 L_qs_15
    s_add_u32 s11, s8, 6144
    buffer_load_dwordx4 v[88:91], v6, s[52:55], s11 offen sc1
    buffer_load_dwordx4 v[92:95], v6, s[52:55], s11 offen offset:1024 sc1
L_qs_15:
    s_bitcmp0_b32 s9, 4
    s_cbranch_scc1 L_qs_16
    s_add_u32 s11, s8, 8192
    buffer_load_dwordx4 v[96:99], v6, s[52:55], s11 offen sc1
    buffer_load_dwordx4 v[100:103], v6, s[52:55], s11 offen offset:1024 sc1
L_qs_16:
    s_bitcmp0_b32 s9, 5
    s_cbranch_scc1 L_qs_17
    s_add_u32 s11, s8, 10240
    buffer_load_dwordx4 v[104:107], v6, s[52:55], s11 offen sc1
    buffer_load_dwordx4 v[108:111], v6, s[52:55], s11 offen offset:1024 sc1
L_qs_17:
    s_bitcmp0_b32 s9, 6
    s_cbranch_scc1 L_qs_18
    s_add_u32 s11, s8, 12288
    buffer_load_dwordx4 v[112:115], v6, s[52:55], s11 offen sc1
    buffer_load_dwordx4 v[116:119], v6, s[52:55], s11 offen offset:1024 sc1
L_qs_18:
    s_bitcmp0_b32 s9, 7
    s_cbranch_scc1 L_qs_19
    s_add_u32 s11, s8, 14336
    buffer_load_dwordx4 v[120:123], v6, s[52:55], s11 offen sc1
    buffer_load_dwordx4 v[124:127], v6, s[52:55], s11 offen offset:1024 sc1
L_qs_19:
    s_bitcmp0_b32 s9, 8
    s_cbranch_scc1 L_qs_20
    buffer_load_dword v46, v47, s[64:67], 0 offen offset:128 sc1
L_qs_20:
    s_waitcnt vmcnt(0)
    v_cmp_ne_u32 vcc, 1, v46
    s_cmp_lg_u64 vcc, 0
    s_cselect_b32 s9, 0x100, 0
    v_xor_b32 v31, s96, v65
    v_xor_b32 v42, s96, v67
    v_xor_b32 v43, s96, v69
    v_xor_b32 v44, s96, v71
    v_or3_b32 v31, v31, v42, v43
    v_or_b32 v31, v31, v44
    v_cmp_ne_u32 vcc, 0, v31
    s_cmp_lg_u64 vcc, 0
    s_cselect_b32 s10, 1, 0
    s_or_b32 s9, s9, s10
    v_xor_b32 v31, s96, v73
    v_xor_b32 v42, s96, v75
    v_xor_b32 v43, s96, v77
    v_xor_b32 v44, s96, v79
    v_or3_b32 v31, v31, v42, v43
    v_or_b32 v31, v31, v44
    v_cmp_ne_u32 vcc, 0, v31
    s_cmp_lg_u64 vcc, 0
    s_cselect_b32 s10, 2, 0
    s_or_b32 s9, s9, s10
    v_xor_b32 v31, s96, v81
    v_xor_b32 v42, s96, v83
    v_xor_b32 v43, s96, v85
    v_xor_b32 v44, s96, v87
    v_or3_b32 v31, v31, v42, v43
    v_or_b32 v31, v31, v44
    v_cmp_ne_u32 vcc, 0, v31
    s_cmp_lg_u64 vcc, 0
    s_cselect_b32 s10, 4, 0
    s_or_b32 s9, s9, s10
    v_xor_b32 v31, s96, v89
    v_xor_b32 v42, s96, v91
    v_xor_b32 v43, s96, v93
    v_xor_b32 v44, s96, v95
    v_or3_b32 v31, v31, v42, v43
    v_or_b32 v31, v31, v44
    v_cmp_ne_u32 vcc, 0, v31
    s_cmp_lg_u64 vcc, 0
    s_cselect_b32 s10, 8, 0
    s_or_b32 s9, s9, s10
    v_xor_b32 v31, s96, v97
    v_xor_b32 v42, s96, v99
    v_xor_b32 v43, s96, v101
    v_xor_b32 v44, s96, v103
    v_or3_b32 v31, v31, v42, v43
    v_or_b32 v31, v31, v44
    v_cmp_ne_u32 vcc, 0, v31
    s_cmp_lg_u64 vcc, 0
    s_cselect_b32 s10, 16, 0
    s_or_b32 s9, s9, s10
    v_xor_b32 v31, s96, v105
    v_xor_b32 v42, s96, v107
    v_xor_b32 v43, s96, v109
    v_xor_b32 v44, s96, v111
    v_or3_b32 v31, v31, v42, v43
    v_or_b32 v31, v31, v44
    v_cmp_ne_u32 vcc, 0, v31
    s_cmp_lg_u64 vcc, 0
    s_cselect_b32 s10, 32, 0
    s_or_b32 s9, s9, s10
    v_xor_b32 v31, s96, v113
    v_xor_b32 v42, s96, v115
    v_xor_b32 v43, s96, v117
    v_xor_b32 v44, s96, v119
    v_or3_b32 v31, v31, v42, v43
    v_or_b32 v31, v31, v44
    v_cmp_ne_u32 vcc, 0, v31
    s_cmp_lg_u64 vcc, 0
    s_cselect_b32 s10, 64, 0
    s_or_b32 s9, s9, s10
    v_xor_b32 v31, s96, v121
    v_xor_b32 v42, s96, v123
    v_xor_b32 v43, s96, v125
    v_xor_b32 v44, s96, v127
    v_or3_b32 v31, v31, v42, v43
    v_or_b32 v31, v31, v44
    v_cmp_ne_u32 vcc, 0, v31
    s_cmp_lg_u64 vcc, 0
    s_cselect_b32 s10, 128, 0
    s_or_b32 s9, s9, s10
    s_cmp_eq_u32 s9, 0
    s_cbranch_scc1 L_qok_11
    s_sub_u32 s13, s13, 1
    s_cmp_gt_i32 s13, 0
    s_cbranch_scc1 L_qp_10
L_qok_11:
    v_add_f32 v64, v64, v96
    v_add_f32 v66, v66, v98
    v_add_f32 v68, v68, v100
    v_add_f32 v70, v70, v102
    v_add_f32 v72, v72, v104
    v_add_f32 v74, v74, v106
    v_add_f32 v76, v76, v108
    v_add_f32 v78, v78, v110
    v_add_f32 v80, v80, v112
    v_add_f32 v82, v82, v114
    v_add_f32 v84, v84, v116
    v_add_f32 v86, v86, v118
    v_add_f32 v88, v88, v120
    v_add_f32 v90, v90, v122
    v_add_f32 v92, v92, v124
    v_add_f32 v94, v94, v126
    v_add_f32 v64, v64, v80
    v_add_f32 v66, v66, v82
    v_add_f32 v68, v68, v84
    v_add_f32 v70, v70, v86
    v_add_f32 v72, v72, v88
    v_add_f32 v74, v74, v90
    v_add_f32 v76, v76, v92
    v_add_f32 v78, v78, v94
    v_add_f32 v64, v64, v72
    v_add_f32 v66, v66, v74
    v_add_f32 v68, v68, v76
    v_add_f32 v70, v70, v78
    v_cvt_pk_bf16_f32 v36, v64, v66
    v_cvt_pk_bf16_f32 v37, v68, v70
    v_mov_b32 v28, 1
    v_mov_b32 v29, 0
    ds_write_b16 v30, v36 offset:14336
    ds_write_b16_d16_hi v30, v36 offset:14352
    ds_write_b16 v30, v37 offset:14368
    ds_write_b16_d16_hi v30, v37 offset:14384
    ds_read_b64 v[36:37], v45 offset:14336
    s_lshl_b32 s8, s4, 10
    s_add_u32 s8, s8, 0x48000
    s_waitcnt lgkmcnt(0)
    v_mov_b32 v32, v36
    v_mov_b32 v34, v37
    buffer_store_dwordx4 v[32:35], v6, s[52:55], s8 offen sc1
    s_barrier
    s_branch L_qdone_9
L_qf_8:
    s_barrier
    s_lshl_b32 s8, s4, 10
    s_add_u32 s8, s8, 0x48000
    s_add_u32 s72, s40, s8
    s_addc_u32 s73, s41, 0
    s_mov_b32 s9, 400
L_probe_21:
    s_load_dword s7, s[72:73], 0x3fc glc
    s_waitcnt lgkmcnt(0)
    s_cmp_eq_u32 s7, s96
    s_cbranch_scc1 L_probed_22
    s_sleep 1
    s_sub_u32 s9, s9, 1
    s_cmp_gt_i32 s9, 0
    s_cbranch_scc1 L_probe_21
L_probed_22:
L_qfl_23:
    buffer_load_dwordx4 v[32:35], v6, s[52:55], s8 offen sc1
    s_waitcnt vmcnt(0)
    v_xor_b32 v42, s96, v33
    v_xor_b32 v43, s96, v35
    v_or_b32 v42, v42, v43
    v_cmp_ne_u32 vcc, 0, v42
    s_cbranch_vccz L_qfok_24
    s_sub_u32 s13, s13, 1
    s_cmp_gt_i32 s13, 0
    s_cbranch_scc1 L_qfl_23
L_qfok_24:
    v_add_u32 v45, 14336, v45
    v_mov_b32 v28, 1
    v_mov_b32 v29, 0
    ds_write2_b32 v45, v32, v34 offset0:0 offset1:1
L_qdone_9:
    ds_write_b32 v29, v28 offset:14988
    s_setprio 0
    buffer_load_dwordx4 v[128:131], v4, s[44:47], s43 offen nt
    buffer_load_dwordx4 v[132:135], v4, s[44:47], s43 offen offset:1024 nt
    buffer_load_dwordx4 v[136:139], v5, s[44:47], s43 offen nt
    buffer_load_dwordx4 v[140:143], v5, s[44:47], s43 offen offset:1024 nt
    buffer_load_dwordx4 v[144:147], v6, s[48:51], s43 offen offset:0 nt
    buffer_load_dwordx4 v[148:151], v6, s[48:51], s43 offen offset:1024 nt
    buffer_load_dwordx4 v[152:155], v6, s[48:51], s43 offen offset:2048 nt
    buffer_load_dwordx4 v[156:159], v6, s[48:51], s43 offen offset:3072 nt
L_waitq_5:
    v_mov_b32 v29, 0
    v_lshlrev_b32 v30, 4, v2
L_qspin_25:
    ds_read_b32 v28, v29 offset:14988
    s_waitcnt lgkmcnt(0)
    v_cmp_eq_u32 vcc, 1, v28
    s_cbranch_vccnz L_qgo_26
    s_sleep 1
    s_branch L_qspin_25
L_qgo_26:
    s_and_b32 s7, s4, 1
    s_lshl_b32 s7, s7, 8
    v_add_u32 v30, s7, v30
    v_xor_b32 v31, 0x100, v30
    ds_read_b128 v[12:15], v30 offset:14336
    ds_read_b128 v[16:19], v31 offset:14336
    v_mov_b32 v20, 0
    v_mov_b32 v21, 0
    v_mov_b32 v22, 0
    v_mov_b32 v23, 0
    v_mov_b32 v24, 0xff7fffff
    v_mov_b32 v25, 0
    s_waitcnt lgkmcnt(0)
    v_mov_b32 v41, 0
    s_mov_b32 s9, 2
    s_cmp_eq_u32 s101, 1
    s_cselect_b32 s97, 1, 1
L_loop_27:
    s_mov_b32 s10, 1
    s_cmp_eq_u32 s97, 0
    s_cbranch_scc1 L_tk_32
    s_atomic_add s10, s[98:99], 0 glc
    s_branch L_tk_33
L_tk_32:
    v_mov_b32 v40, 1
    s_mov_b32 exec_lo, 0x1
    s_mov_b32 exec_hi, 0x0
    ds_add_rtn_u32 v40, v41, v40 offset:14984
    s_mov_b64 exec, -1
L_tk_33:
    s_waitcnt vmcnt(4)
    v_dot2_f32_bf16 v26, v128, v12, 0
    v_dot2_f32_bf16 v27, v132, v12, 0
    v_dot2_f32_bf16 v28, v136, v12, 0
    v_dot2_f32_bf16 v29, v140, v12, 0
    v_dot2_f32_bf16 v26, v129, v13, v26
    v_dot2_f32_bf16 v27, v133, v13, v27
    v_dot2_f32_bf16 v28, v137, v13, v28
    v_dot2_f32_bf16 v29, v141, v13, v29
    v_dot2_f32_bf16 v26, v130, v14, v26
    v_dot2_f32_bf16 v27, v134, v14, v27
    v_dot2_f32_bf16 v28, v138, v14, v28
    v_dot2_f32_bf16 v29, v142, v14, v29
    v_dot2_f32_bf16 v26, v131, v15, v26
    v_dot2_f32_bf16 v27, v135, v15, v27
    v_dot2_f32_bf16 v28, v139, v15, v28
    v_dot2_f32_bf16 v29, v143, v15, v29
    s_waitcnt lgkmcnt(0)
    s_cmp_eq_u32 s97, 1
    s_cbranch_scc1 L_tk_34
    v_readfirstlane_b32 s7, v40
    s_nop 0
    s_add_u32 s7, s7, 22
    s_lshl_b32 s11, s7, 12
    s_add_u32 s11, s11, s95
    s_and_b32 s11, s11, 0xfffff
    s_add_u32 s11, s11, s100
    s_mov_b32 s10, -1
    s_cmp_lt_u32 s7, 22
    s_cbranch_scc1 L_tk_35
    s_mov_b32 s97, 1
    s_mov_b32 s10, 1
    s_atomic_add s10, s[98:99], 0 glc
    s_waitcnt lgkmcnt(0)
L_tk_34:
    s_cmp_lt_u32 s10, 122
    s_cselect_b32 s7, s100, s12
    s_add_u32 s11, s10, s6
    s_and_b32 s11, s11, 255
    s_lshl_b32 s11, s11, 12
    s_add_u32 s11, s11, s7
    s_cmp_lt_u32 s10, 378
    s_cselect_b32 s11, s11, 0x4000000
L_tk_35:
    v_add_f32_dpp v30, v28, v26 row_ror:8 row_mask:0xf bank_mask:0xf
    v_add_f32_dpp v31, v29, v27 row_ror:8 row_mask:0xf bank_mask:0xf
    s_cmp_lg_u32 s11, 0x4000000
    s_cselect_b32 s7, 0, s9
    s_cmp_eq_u32 s7, 1
    s_cbranch_scc1 L_final_36
    buffer_load_dwordx4 v[128:131], v4, s[44:47], s11 offen nt
    buffer_load_dwordx4 v[132:135], v4, s[44:47], s11 offen offset:1024 nt
    buffer_load_dwordx4 v[136:139], v5, s[44:47], s11 offen nt
    buffer_load_dwordx4 v[140:143], v5, s[44:47], s11 offen offset:1024 nt
    v_add_f32_dpp v32, v30, v30 row_shl:4 row_mask:0xf bank_mask:0x5
    v_add_f32_dpp v32, v31, v31 row_shr:4 row_mask:0xf bank_mask:0xa
    s_nop 1
    v_add_f32_dpp v32, v32, v32 quad_perm:[2,3,0,1] row_mask:0xf bank_mask:0xf
    s_nop 1
    v_add_f32_dpp v32, v32, v32 quad_perm:[1,0,3,2] row_mask:0xf bank_mask:0xf
    v_cvt_pk_bf16_f32 v33, v32, v32
    v_and_b32 v33, 0xffff0000, v33
    v_mul_f32 v33, s68, v33
    v_cvt_pk_bf16_f32 v33, v33, v33
    v_and_b32 v33, 0xffff0000, v33
    s_nop 1
    v_max_f32_dpp v34, v33, v33 row_ror:4 row_mask:0xf bank_mask:0xf
    s_nop 1
    v_max_f32_dpp v34, v34, v34 row_ror:8 row_mask:0xf bank_mask:0xf
    v_mov_b32 v35, v34
    s_nop 1
    v_permlane16_swap_b32 v34, v35
    s_nop 0
    v_max_f32 v34, v34, v35
    v_mov_b32 v35, v34
    s_nop 1
    v_permlane32_swap_b32 v34, v35
    s_nop 0
    v_max_f32 v34, v34, v35
    v_max_f32 v34, v34, v24
    v_sub_f32 v37, v33, v34
    v_sub_f32 v36, v24, v34
    v_mul_f32 v37, s69, v37
    v_mul_f32 v36, s69, v36
    v_exp_f32 v37, v37
    v_exp_f32 v36, v36
    v_mov_b32 v24, v34
    v_cvt_pk_bf16_f32 v38, v37, v37
    v_mul_f32 v20, v20, v36
    v_mul_f32 v21, v21, v36
    v_mul_f32 v22, v22, v36
    v_mul_f32 v23, v23, v36
    v_add_f32_dpp v39, v37, v37 row_ror:4 row_mask:0xf bank_mask:0xf
    v_and_b32_dpp v48, v38, v8 row_newbcast:0 row_mask:0xf bank_mask:0xf
    v_and_b32_dpp v49, v38, v9 row_newbcast:0 row_mask:0xf bank_mask:0xf
    v_and_b32_dpp v50, v38, v10 row_newbcast:0 row_mask:0xf bank_mask:0xf
    v_and_b32_dpp v51, v38, v11 row_newbcast:0 row_mask:0xf bank_mask:0xf
    v_add_f32_dpp v39, v39, v39 row_ror:8 row_mask:0xf bank_mask:0xf
    v_and_b32_dpp v52, v38, v8 row_newbcast:4 row_mask:0xf bank_mask:0xf
    v_and_b32_dpp v53, v38, v9 row_newbcast:4 row_mask:0xf bank_mask:0xf
    v_and_b32_dpp v54, v38, v10 row_newbcast:4 row_mask:0xf bank_mask:0xf
    v_and_b32_dpp v55, v38, v11 row_newbcast:4 row_mask:0xf bank_mask:0xf
    v_mov_b32 v35, v39
    s_nop 1
    v_permlane16_swap_b32 v39, v35
    s_nop 0
    v_add_f32 v39, v39, v35
    v_mov_b32 v35, v39
    s_nop 1
    v_permlane32_swap_b32 v39, v35
    s_nop 0
    v_add_f32 v39, v39, v35
    v_fma_f32 v25, v25, v36, v39
    s_waitcnt vmcnt(7)
    v_mfma_f32_16x16x32_bf16 v[20:23], v[144:147], v[48:51], v[20:23]
    s_waitcnt vmcnt(6)
    v_mfma_f32_16x16x32_bf16 v[20:23], v[148:151], v[52:55], v[20:23]
    v_and_b32_dpp v48, v38, v8 row_newbcast:8 row_mask:0xf bank_mask:0xf
    v_and_b32_dpp v49, v38, v9 row_newbcast:8 row_mask:0xf bank_mask:0xf
    v_and_b32_dpp v50, v38, v10 row_newbcast:8 row_mask:0xf bank_mask:0xf
    v_and_b32_dpp v51, v38, v11 row_newbcast:8 row_mask:0xf bank_mask:0xf
    s_nop 0
    s_waitcnt vmcnt(5)
    v_mfma_f32_16x16x32_bf16 v[20:23], v[152:155], v[48:51], v[20:23]
    v_and_b32_dpp v52, v38, v8 row_newbcast:12 row_mask:0xf bank_mask:0xf
    v_and_b32_dpp v53, v38, v9 row_newbcast:12 row_mask:0xf bank_mask:0xf
    v_and_b32_dpp v54, v38, v10 row_newbcast:12 row_mask:0xf bank_mask:0xf
    v_and_b32_dpp v55, v38, v11 row_newbcast:12 row_mask:0xf bank_mask:0xf
    s_nop 0
    s_waitcnt vmcnt(4)
    v_mfma_f32_16x16x32_bf16 v[20:23], v[156:159], v[52:55], v[20:23]
    buffer_load_dwordx4 v[144:147], v6, s[48:51], s11 offen offset:0 nt
    buffer_load_dwordx4 v[148:151], v6, s[48:51], s11 offen offset:1024 nt
    buffer_load_dwordx4 v[152:155], v6, s[48:51], s11 offen offset:2048 nt
    buffer_load_dwordx4 v[156:159], v6, s[48:51], s11 offen offset:3072 nt
    s_cmp_eq_u32 s9, 2
    s_cbranch_scc1 L_extra_30
L_cont_31:
    s_cmp_lt_i32 s10, 122
    s_cbranch_scc1 L_loop_27
    s_cmp_eq_u32 s9, 0
    s_cbranch_scc1 L_switch_29
L_chk_38:
    s_cmp_lt_u32 s10, 314
    s_cbranch_scc1 L_loop_27
    s_cmp_ge_u32 s10, 378
    s_cbranch_scc1 L_exit_28
    s_cmp_lt_u32 s3, 4
    s_cbranch_scc1 L_loop_27
    s_waitcnt vmcnt(4)
    v_dot2_f32_bf16 v26, v128, v12, 0
    v_dot2_f32_bf16 v27, v132, v12, 0
    v_dot2_f32_bf16 v28, v136, v12, 0
    v_dot2_f32_bf16 v29, v140, v12, 0
    v_dot2_f32_bf16 v26, v129, v13, v26
    v_dot2_f32_bf16 v27, v133, v13, v27
    v_dot2_f32_bf16 v28, v137, v13, v28
    v_dot2_f32_bf16 v29, v141, v13, v29
    v_dot2_f32_bf16 v26, v130, v14, v26
    v_dot2_f32_bf16 v27, v134, v14, v27
    v_dot2_f32_bf16 v28, v138, v14, v28
    v_dot2_f32_bf16 v29, v142, v14, v29
    v_dot2_f32_bf16 v26, v131, v15, v26
    v_dot2_f32_bf16 v27, v135, v15, v27
    v_dot2_f32_bf16 v28, v139, v15, v28
    v_dot2_f32_bf16 v29, v143, v15, v29
    s_nop 2
    v_add_f32_dpp v30, v28, v26 row_ror:8 row_mask:0xf bank_mask:0xf
    v_add_f32_dpp v31, v29, v27 row_ror:8 row_mask:0xf bank_mask:0xf
    s_nop 0
L_final_36:
    v_add_f32_dpp v32, v30, v30 row_shl:4 row_mask:0xf bank_mask:0x5
    v_add_f32_dpp v32, v31, v31 row_shr:4 row_mask:0xf bank_mask:0xa
    s_nop 1
    v_add_f32_dpp v32, v32, v32 quad_perm:[2,3,0,1] row_mask:0xf bank_mask:0xf
    s_nop 1
    v_add_f32_dpp v32, v32, v32 quad_perm:[1,0,3,2] row_mask:0xf bank_mask:0xf
    v_cvt_pk_bf16_f32 v33, v32, v32
    v_and_b32 v33, 0xffff0000, v33
    v_mul_f32 v33, s68, v33
    v_cvt_pk_bf16_f32 v33, v33, v33
    v_and_b32 v33, 0xffff0000, v33
    s_nop 1
    v_max_f32_dpp v34, v33, v33 row_ror:4 row_mask:0xf bank_mask:0xf
    s_nop 1
    v_max_f32_dpp v34, v34, v34 row_ror:8 row_mask:0xf bank_mask:0xf
    v_mov_b32 v35, v34
    s_nop 1
    v_permlane16_swap_b32 v34, v35
    s_nop 0
    v_max_f32 v34, v34, v35
    v_mov_b32 v35, v34
    s_nop 1
    v_permlane32_swap_b32 v34, v35
    s_nop 0
    v_max_f32 v34, v34, v35
    v_max_f32 v34, v34, v24
    v_sub_f32 v37, v33, v34
    v_sub_f32 v36, v24, v34
    v_mul_f32 v37, s69, v37
    v_mul_f32 v36, s69, v36
    v_exp_f32 v37, v37
    v_exp_f32 v36, v36
    v_mov_b32 v24, v34
    v_cvt_pk_bf16_f32 v38, v37, v37
    v_mul_f32 v20, v20, v36
    v_mul_f32 v21, v21, v36
    v_mul_f32 v22, v22, v36
    v_mul_f32 v23, v23, v36
    v_add_f32_dpp v39, v37, v37 row_ror:4 row_mask:0xf bank_mask:0xf
    v_and_b32_dpp v48, v38, v8 row_newbcast:0 row_mask:0xf bank_mask:0xf
    v_and_b32_dpp v49, v38, v9 row_newbcast:0 row_mask:0xf bank_mask:0xf
    v_and_b32_dpp v50, v38, v10 row_newbcast:0 row_mask:0xf bank_mask:0xf
    v_and_b32_dpp v51, v38, v11 row_newbcast:0 row_mask:0xf bank_mask:0xf
    v_add_f32_dpp v39, v39, v39 row_ror:8 row_mask:0xf bank_mask:0xf
    v_and_b32_dpp v52, v38, v8 row_newbcast:4 row_mask:0xf bank_mask:0xf
    v_and_b32_dpp v53, v38, v9 row_newbcast:4 row_mask:0xf bank_mask:0xf
    v_and_b32_dpp v54, v38, v10 row_newbcast:4 row_mask:0xf bank_mask:0xf
    v_and_b32_dpp v55, v38, v11 row_newbcast:4 row_mask:0xf bank_mask:0xf
    v_mov_b32 v35, v39
    s_nop 1
    v_permlane16_swap_b32 v39, v35
    s_nop 0
    v_add_f32 v39, v39, v35
    v_mov_b32 v35, v39
    s_nop 1
    v_permlane32_swap_b32 v39, v35
    s_nop 0
    v_add_f32 v39, v39, v35
    v_fma_f32 v25, v25, v36, v39
    s_waitcnt vmcnt(3)
    v_mfma_f32_16x16x32_bf16 v[20:23], v[144:147], v[48:51], v[20:23]
    s_waitcnt vmcnt(2)
    v_mfma_f32_16x16x32_bf16 v[20:23], v[148:151], v[52:55], v[20:23]
    v_and_b32_dpp v48, v38, v8 row_newbcast:8 row_mask:0xf bank_mask:0xf
    v_and_b32_dpp v49, v38, v9 row_newbcast:8 row_mask:0xf bank_mask:0xf
    v_and_b32_dpp v50, v38, v10 row_newbcast:8 row_mask:0xf bank_mask:0xf
    v_and_b32_dpp v51, v38, v11 row_newbcast:8 row_mask:0xf bank_mask:0xf
    s_nop 0
    s_waitcnt vmcnt(1)
    v_mfma_f32_16x16x32_bf16 v[20:23], v[152:155], v[48:51], v[20:23]
    v_and_b32_dpp v52, v38, v8 row_newbcast:12 row_mask:0xf bank_mask:0xf
    v_and_b32_dpp v53, v38, v9 row_newbcast:12 row_mask:0xf bank_mask:0xf
    v_and_b32_dpp v54, v38, v10 row_newbcast:12 row_mask:0xf bank_mask:0xf
    v_and_b32_dpp v55, v38, v11 row_newbcast:12 row_mask:0xf bank_mask:0xf
    s_nop 0
    s_waitcnt vmcnt(0)
    v_mfma_f32_16x16x32_bf16 v[20:23], v[156:159], v[52:55], v[20:23]
    s_branch L_exit_28
L_extra_30:
    s_cmp_eq_u32 s3, 0
    s_cbranch_scc1 L_qw_39
    s_cmp_eq_u32 s101, 1
    s_cbranch_scc1 L_join_40
    s_waitcnt vmcnt(8)
    v_dot2_f32_bf16 v26, v160, v12, 0
    v_dot2_f32_bf16 v27, v164, v12, 0
    v_dot2_f32_bf16 v28, v168, v12, 0
    v_dot2_f32_bf16 v29, v172, v12, 0
    v_dot2_f32_bf16 v26, v161, v13, v26
    v_dot2_f32_bf16 v27, v165, v13, v27
    v_dot2_f32_bf16 v28, v169, v13, v28
    v_dot2_f32_bf16 v29, v173, v13, v29
    v_dot2_f32_bf16 v26, v162, v14, v26
    v_dot2_f32_bf16 v27, v166, v14, v27
    v_dot2_f32_bf16 v28, v170, v14, v28
    v_dot2_f32_bf16 v29, v174, v14, v29
    v_dot2_f32_bf16 v26, v163, v15, v26
    v_dot2_f32_bf16 v27, v167, v15, v27
    v_dot2_f32_bf16 v28, v171, v15, v28
    v_dot2_f32_bf16 v29, v175, v15, v29
    s_nop 2
    v_add_f32_dpp v30, v28, v26 row_ror:8 row_mask:0xf bank_mask:0xf
    v_add_f32_dpp v31, v29, v27 row_ror:8 row_mask:0xf bank_mask:0xf
    s_nop 0
    v_add_f32_dpp v32, v30, v30 row_shl:4 row_mask:0xf bank_mask:0x5
    v_add_f32_dpp v32, v31, v31 row_shr:4 row_mask:0xf bank_mask:0xa
    s_nop 1
    v_add_f32_dpp v32, v32, v32 quad_perm:[2,3,0,1] row_mask:0xf bank_mask:0xf
    s_nop 1
    v_add_f32_dpp v32, v32, v32 quad_perm:[1,0,3,2] row_mask:0xf bank_mask:0xf
    v_cvt_pk_bf16_f32 v33, v32, v32
    v_and_b32 v33, 0xffff0000, v33
    v_mul_f32 v33, s68, v33
    v_cvt_pk_bf16_f32 v33, v33, v33
    v_and_b32 v33, 0xffff0000, v33
    s_nop 1
    v_max_f32_dpp v34, v33, v33 row_ror:4 row_mask:0xf bank_mask:0xf
    s_nop 1
    v_max_f32_dpp v34, v34, v34 row_ror:8 row_mask:0xf bank_mask:0xf
    v_mov_b32 v35, v34
    s_nop 1
    v_permlane16_swap_b32 v34, v35
    s_nop 0
    v_max_f32 v34, v34, v35
    v_mov_b32 v35, v34
    s_nop 1
    v_permlane32_swap_b32 v34, v35
    s_nop 0
    v_max_f32 v34, v34, v35
    v_max_f32 v34, v34, v24
    v_sub_f32 v37, v33, v34
    v_sub_f32 v36, v24, v34
    v_mul_f32 v37, s69, v37
    v_mul_f32 v36, s69, v36
    v_exp_f32 v37, v37
    v_exp_f32 v36, v36
    v_mov_b32 v24, v34
    v_cvt_pk_bf16_f32 v38, v37, v37
    v_mul_f32 v20, v20, v36
    v_mul_f32 v21, v21, v36
    v_mul_f32 v22, v22, v36
    v_mul_f32 v23, v23, v36
    v_add_f32_dpp v39, v37, v37 row_ror:4 row_mask:0xf bank_mask:0xf
    v_and_b32_dpp v48, v38, v8 row_newbcast:0 row_mask:0xf bank_mask:0xf
    v_and_b32_dpp v49, v38, v9 row_newbcast:0 row_mask:0xf bank_mask:0xf
    v_and_b32_dpp v50, v38, v10 row_newbcast:0 row_mask:0xf bank_mask:0xf
    v_and_b32_dpp v51, v38, v11 row_newbcast:0 row_mask:0xf bank_mask:0xf
    v_add_f32_dpp v39, v39, v39 row_ror:8 row_mask:0xf bank_mask:0xf
    v_and_b32_dpp v52, v38, v8 row_newbcast:4 row_mask:0xf bank_mask:0xf
    v_and_b32_dpp v53, v38, v9 row_newbcast:4 row_mask:0xf bank_mask:0xf
    v_and_b32_dpp v54, v38, v10 row_newbcast:4 row_mask:0xf bank_mask:0xf
    v_and_b32_dpp v55, v38, v11 row_newbcast:4 row_mask:0xf bank_mask:0xf
    v_mov_b32 v35, v39
    s_nop 1
    v_permlane16_swap_b32 v39, v35
    s_nop 0
    v_add_f32 v39, v39, v35
    v_mov_b32 v35, v39
    s_nop 1
    v_permlane32_swap_b32 v39, v35
    s_nop 0
    v_add_f32 v39, v39, v35
    v_fma_f32 v25, v25, v36, v39
    s_nop 0
    v_mfma_f32_16x16x32_bf16 v[20:23], v[176:179], v[48:51], v[20:23]
    s_nop 0
    v_mfma_f32_16x16x32_bf16 v[20:23], v[180:183], v[52:55], v[20:23]
    v_and_b32_dpp v48, v38, v8 row_newbcast:8 row_mask:0xf bank_mask:0xf
    v_and_b32_dpp v49, v38, v9 row_newbcast:8 row_mask:0xf bank_mask:0xf
    v_and_b32_dpp v50, v38, v10 row_newbcast:8 row_mask:0xf bank_mask:0xf
    v_and_b32_dpp v51, v38, v11 row_newbcast:8 row_mask:0xf bank_mask:0xf
    s_nop 0
    s_nop 0
    v_mfma_f32_16x16x32_bf16 v[20:23], v[184:187], v[48:51], v[20:23]
    v_and_b32_dpp v52, v38, v8 row_newbcast:12 row_mask:0xf bank_mask:0xf
    v_and_b32_dpp v53, v38, v9 row_newbcast:12 row_mask:0xf bank_mask:0xf
    v_and_b32_dpp v54, v38, v10 row_newbcast:12 row_mask:0xf bank_mask:0xf
    v_and_b32_dpp v55, v38, v11 row_newbcast:12 row_mask:0xf bank_mask:0xf
    s_nop 0
    s_nop 0
    v_mfma_f32_16x16x32_bf16 v[20:23], v[188:191], v[52:55], v[20:23]
    s_waitcnt vmcnt(8)
    v_dot2_f32_bf16 v26, v192, v12, 0
    v_dot2_f32_bf16 v27, v196, v12, 0
    v_dot2_f32_bf16 v28, v200, v12, 0
    v_dot2_f32_bf16 v29, v204, v12, 0
    v_dot2_f32_bf16 v26, v193, v13, v26
    v_dot2_f32_bf16 v27, v197, v13, v27
    v_dot2_f32_bf16 v28, v201, v13, v28
    v_dot2_f32_bf16 v29, v205, v13, v29
    v_dot2_f32_bf16 v26, v194, v14, v26
    v_dot2_f32_bf16 v27, v198, v14, v27
    v_dot2_f32_bf16 v28, v202, v14, v28
    v_dot2_f32_bf16 v29, v206, v14, v29
    v_dot2_f32_bf16 v26, v195, v15, v26
    v_dot2_f32_bf16 v27, v199, v15, v27
    v_dot2_f32_bf16 v28, v203, v15, v28
    v_dot2_f32_bf16 v29, v207, v15, v29
    s_nop 2
    v_add_f32_dpp v30, v28, v26 row_ror:8 row_mask:0xf bank_mask:0xf
    v_add_f32_dpp v31, v29, v27 row_ror:8 row_mask:0xf bank_mask:0xf
    s_nop 0
    v_add_f32_dpp v32, v30, v30 row_shl:4 row_mask:0xf bank_mask:0x5
    v_add_f32_dpp v32, v31, v31 row_shr:4 row_mask:0xf bank_mask:0xa
    s_nop 1
    v_add_f32_dpp v32, v32, v32 quad_perm:[2,3,0,1] row_mask:0xf bank_mask:0xf
    s_nop 1
    v_add_f32_dpp v32, v32, v32 quad_perm:[1,0,3,2] row_mask:0xf bank_mask:0xf
    v_cvt_pk_bf16_f32 v33, v32, v32
    v_and_b32 v33, 0xffff0000, v33
    v_mul_f32 v33, s68, v33
    v_cvt_pk_bf16_f32 v33, v33, v33
    v_and_b32 v33, 0xffff0000, v33
    s_nop 1
    v_max_f32_dpp v34, v33, v33 row_ror:4 row_mask:0xf bank_mask:0xf
    s_nop 1
    v_max_f32_dpp v34, v34, v34 row_ror:8 row_mask:0xf bank_mask:0xf
    v_mov_b32 v35, v34
    s_nop 1
    v_permlane16_swap_b32 v34, v35
    s_nop 0
    v_max_f32 v34, v34, v35
    v_mov_b32 v35, v34
    s_nop 1
    v_permlane32_swap_b32 v34, v35
    s_nop 0
    v_max_f32 v34, v34, v35
    v_max_f32 v34, v34, v24
    v_sub_f32 v37, v33, v34
    v_sub_f32 v36, v24, v34
    v_mul_f32 v37, s69, v37
    v_mul_f32 v36, s69, v36
    v_exp_f32 v37, v37
    v_exp_f32 v36, v36
    v_mov_b32 v24, v34
    v_cvt_pk_bf16_f32 v38, v37, v37
    v_mul_f32 v20, v20, v36
    v_mul_f32 v21, v21, v36
    v_mul_f32 v22, v22, v36
    v_mul_f32 v23, v23, v36
    v_add_f32_dpp v39, v37, v37 row_ror:4 row_mask:0xf bank_mask:0xf
    v_and_b32_dpp v48, v38, v8 row_newbcast:0 row_mask:0xf bank_mask:0xf
    v_and_b32_dpp v49, v38, v9 row_newbcast:0 row_mask:0xf bank_mask:0xf
    v_and_b32_dpp v50, v38, v10 row_newbcast:0 row_mask:0xf bank_mask:0xf
    v_and_b32_dpp v51, v38, v11 row_newbcast:0 row_mask:0xf bank_mask:0xf
    v_add_f32_dpp v39, v39, v39 row_ror:8 row_mask:0xf bank_mask:0xf
    v_and_b32_dpp v52, v38, v8 row_newbcast:4 row_mask:0xf bank_mask:0xf
    v_and_b32_dpp v53, v38, v9 row_newbcast:4 row_mask:0xf bank_mask:0xf
    v_and_b32_dpp v54, v38, v10 row_newbcast:4 row_mask:0xf bank_mask:0xf
    v_and_b32_dpp v55, v38, v11 row_newbcast:4 row_mask:0xf bank_mask:0xf
    v_mov_b32 v35, v39
    s_nop 1
    v_permlane16_swap_b32 v39, v35
    s_nop 0
    v_add_f32 v39, v39, v35
    v_mov_b32 v35, v39
    s_nop 1
    v_permlane32_swap_b32 v39, v35
    s_nop 0
    v_add_f32 v39, v39, v35
    v_fma_f32 v25, v25, v36, v39
    s_nop 0
    v_mfma_f32_16x16x32_bf16 v[20:23], v[208:211], v[48:51], v[20:23]
    s_nop 0
    v_mfma_f32_16x16x32_bf16 v[20:23], v[212:215], v[52:55], v[20:23]
    v_and_b32_dpp v48, v38, v8 row_newbcast:8 row_mask:0xf bank_mask:0xf
    v_and_b32_dpp v49, v38, v9 row_newbcast:8 row_mask:0xf bank_mask:0xf
    v_and_b32_dpp v50, v38, v10 row_newbcast:8 row_mask:0xf bank_mask:0xf
    v_and_b32_dpp v51, v38, v11 row_newbcast:8 row_mask:0xf bank_mask:0xf
    s_nop 0
    s_nop 0
    v_mfma_f32_16x16x32_bf16 v[20:23], v[216:219], v[48:51], v[20:23]
    v_and_b32_dpp v52, v38, v8 row_newbcast:12 row_mask:0xf bank_mask:0xf
    v_and_b32_dpp v53, v38, v9 row_newbcast:12 row_mask:0xf bank_mask:0xf
    v_and_b32_dpp v54, v38, v10 row_newbcast:12 row_mask:0xf bank_mask:0xf
    v_and_b32_dpp v55, v38, v11 row_newbcast:12 row_mask:0xf bank_mask:0xf
    s_nop 0
    s_nop 0
    v_mfma_f32_16x16x32_bf16 v[20:23], v[220:223], v[52:55], v[20:23]
    s_branch L_join_40
L_qw_39:
    s_cmp_eq_u32 s14, 0
    s_cbranch_scc1 L_join_40
    s_call_b64 s[72:73], L_prep
    s_cmp_lg_u32 s14, 2
    s_cbranch_scc1 L_join_40
    s_getreg_b32 s7, hwreg(HW_REG_XCC_ID)
    s_and_b32 s7, s7, 15
    v_mov_b32 v26, s7
    s_lshl_b32 s7, s15, 2
    s_add_u32 s7, s7, 0x2b800
    buffer_store_dword v26, v7, s[52:55], s7 offen sc1
L_join_40:
    s_mov_b32 s9, 0
    s_branch L_cont_31
L_switch_29:
    s_lshl_b32 s7, s3, 10
    v_add_u32 v34, s7, v6
    s_lshl_b32 s7, s3, 3
    v_mov_b32 v35, s7
    v_mov_b32 v36, 1
    v_and_b32 v26, 7, v2
    v_lshl_add_u32 v27, v3, 4, v26
    v_lshrrev_b32 v28, 3, v2
    ds_write_b64 v35, v[24:25] offset:14848
    ds_write_b128 v34, v[20:23] offset:18432
    v_lshlrev_b32 v29, 5, v28
    v_lshlrev_b32 v27, 4, v27
    s_mov_b32 exec_lo, 0x1
    s_mov_b32 exec_hi, 0x0
    ds_add_rtn_u32 v36, v41, v36 offset:14976
    s_mov_b64 exec, -1
    v_xor_b32 v30, 32, v29
    v_lshl_add_u32 v27, v28, 12, v27
    ds_read_b128 v[80:83], v29 offset:14848
    ds_read_b128 v[84:87], v29 offset:14864
    ds_read_b128 v[88:91], v30 offset:14848
    ds_read_b128 v[92:95], v30 offset:14864
    ds_read_b128 v[64:67], v27 offset:18432
    ds_read_b128 v[68:71], v27 offset:19456
    ds_read_b128 v[72:75], v27 offset:20480
    ds_read_b128 v[76:79], v27 offset:21504
    s_mov_b32 s94, 0
    s_waitcnt lgkmcnt(8)
    v_readfirstlane_b32 s7, v36
    s_nop 0
    s_cmp_lg_u32 s7, 7
    s_cbranch_scc1 L_nocomb_41
    s_call_b64 s[72:73], L_combine
L_nocomb_41:
    s_waitcnt lgkmcnt(0)
    v_mov_b32 v20, 0
    v_mov_b32 v21, 0
    v_mov_b32 v22, 0
    v_mov_b32 v23, 0
    v_mov_b32 v24, 0xff7fffff
    v_mov_b32 v25, 0
    v_mov_b32 v12, v16
    v_mov_b32 v13, v17
    v_mov_b32 v14, v18
    v_mov_b32 v15, v19
    s_mov_b32 s9, 1
    s_branch L_chk_38
L_exit_28:
    s_lshl_b32 s7, s3, 10
    v_add_u32 v34, s7, v6
    s_lshl_b32 s7, s3, 3
    v_mov_b32 v35, s7
    v_mov_b32 v36, 1
    v_and_b32 v26, 7, v2
    v_lshl_add_u32 v27, v3, 4, v26
    v_lshrrev_b32 v28, 3, v2
    ds_write_b64 v35, v[24:25] offset:14912
    ds_write_b128 v34, v[20:23] offset:26624
    v_lshlrev_b32 v29, 5, v28
    v_lshlrev_b32 v27, 4, v27
    s_mov_b32 exec_lo, 0x1
    s_mov_b32 exec_hi, 0x0
    ds_add_rtn_u32 v36, v41, v36 offset:14980
    s_mov_b64 exec, -1
    v_xor_b32 v30, 32, v29
    v_lshl_add_u32 v27, v28, 12, v27
    ds_read_b128 v[80:83], v29 offset:14912
    ds_read_b128 v[84:87], v29 offset:14928
    ds_read_b128 v[88:91], v30 offset:14912
    ds_read_b128 v[92:95], v30 offset:14928
    ds_read_b128 v[64:67], v27 offset:26624
    ds_read_b128 v[68:71], v27 offset:27648
    ds_read_b128 v[72:75], v27 offset:28672
    ds_read_b128 v[76:79], v27 offset:29696
    s_mov_b32 s94, 1
    s_waitcnt lgkmcnt(8)
    v_readfirstlane_b32 s7, v36
    s_nop 0
    s_cmp_lg_u32 s7, 7
    s_cbranch_scc1 L_nocomb_42
    s_call_b64 s[72:73], L_combine
L_nocomb_42:
    s_waitcnt lgkmcnt(0)
    s_cmp_eq_u32 s14, 0
    s_cbranch_scc1 L_fin_44
L_tail:
    s_mov_b32 s13, 262143
    s_cmp_lg_u32 s14, 1
    s_cbranch_scc1 L_next_45
    v_lshlrev_b32 v26, 8, v2
    v_lshl_add_u32 v26, v3, 4, v26
    s_and_b32 s7, s4, 24
    s_add_u32 s7, s7, s3
    s_lshl_b32 s8, s7, 11
    s_add_u32 s8, s8, 0x30000
    s_lshl_b32 s7, s7, 12
    v_and_b32 v27, 7, v2
    v_and_b32 v28, 1, v3
    v_lshlrev_b32 v28, 2, v28
    v_xor_b32 v27, v27, v28
    v_lshlrev_b32 v27, 7, v27
    v_lshrrev_b32 v28, 1, v3
    v_lshl_add_u32 v27, v28, 10, v27
    v_mov_b32 v39, 1
    v_mov_b32 v45, 0
L_wp_46:
    buffer_load_dwordx4 v[64:67], v26, s[52:55], s7 offen offset:0 sc1
    buffer_load_dwordx4 v[68:71], v26, s[52:55], s7 offen offset:64 sc1
    buffer_load_dwordx4 v[72:75], v26, s[52:55], s7 offen offset:128 sc1
    buffer_load_dwordx4 v[76:79], v26, s[52:55], s7 offen offset:192 sc1
    buffer_load_dwordx2 v[80:81], v27, s[52:55], s8 offen sc1
    s_mov_b64 exec, -1
    s_sub_u32 s13, s13, 1
    s_waitcnt vmcnt(0)
    v_mfma_f32_16x16x32_bf16 v[128:131], v[64:67], v[160:163], 0
    v_max3_u32 v31, v64, v65, v66
    v_max3_u32 v32, v73, v74, v75
    v_mfma_f32_16x16x32_bf16 v[128:131], v[68:71], v[176:179], v[128:131]
    v_max3_u32 v31, v31, v67, v68
    v_max3_u32 v32, v32, v76, v77
    v_mfma_f32_16x16x32_bf16 v[128:131], v[72:75], v[192:195], v[128:131]
    v_max3_u32 v31, v31, v69, v70
    v_max3_u32 v32, v32, v78, v79
    v_mfma_f32_16x16x32_bf16 v[128:131], v[76:79], v[208:211], v[128:131]
    v_max3_u32 v31, v31, v71, v72
    v_max3_u32 v32, v32, v80, v81
    v_max_u32 v31, v31, v32
    v_cmp_eq_u32 vcc, -1, v31
    s_cbranch_vccz L_wok_47
    s_mov_b64 exec, vcc
    s_cmp_gt_i32 s13, 0
    s_cbranch_scc1 L_wp_46
    s_mov_b64 exec, -1
L_wok_47:
    v_mfma_f32_16x16x32_bf16 v[132:135], v[64:67], v[164:167], 0
    v_max_f32_dpp v36, v80, v80 quad_perm:[1,0,3,2] row_mask:0xf bank_mask:0xf
    s_lshl_b32 s11, s3, 10
    v_mfma_f32_16x16x32_bf16 v[132:135], v[68:71], v[180:183], v[132:135]
    v_max_f32_dpp v36, v36, v36 quad_perm:[2,3,0,1] row_mask:0xf bank_mask:0xf
    v_add_u32 v30, s11, v6
    v_mfma_f32_16x16x32_bf16 v[132:135], v[72:75], v[196:199], v[132:135]
    v_max_f32_dpp v36, v36, v36 row_half_mirror row_mask:0xf bank_mask:0xf
    v_sub_f32 v37, v80, v36
    v_mfma_f32_16x16x32_bf16 v[132:135], v[76:79], v[212:215], v[132:135]
    v_mul_f32 v37, s69, v37
    v_exp_f32 v37, v37
    v_mfma_f32_16x16x32_bf16 v[136:139], v[64:67], v[168:171], 0
    v_mul_f32 v38, v37, v81
    v_lshlrev_b32 v26, 11, v28
    v_mfma_f32_16x16x32_bf16 v[136:139], v[68:71], v[184:187], v[136:139]
    v_add_f32_dpp v38, v38, v38 quad_perm:[1,0,3,2] row_mask:0xf bank_mask:0xf
    v_lshl_add_u32 v26, v2, 4, v26
    v_mfma_f32_16x16x32_bf16 v[136:139], v[72:75], v[200:203], v[136:139]
    v_add_f32_dpp v38, v38, v38 quad_perm:[2,3,0,1] row_mask:0xf bank_mask:0xf
    s_lshr_b32 s7, s4, 3
    v_mfma_f32_16x16x32_bf16 v[136:139], v[76:79], v[216:219], v[136:139]
    v_add_f32_dpp v38, v38, v38 row_half_mirror row_mask:0xf bank_mask:0xf
    v_rcp_f32 v38, v38
    v_mfma_f32_16x16x32_bf16 v[140:143], v[64:67], v[172:175], 0
    s_lshl_b32 s7, s7, 12
    v_mul_f32 v37, v37, v38
    v_mfma_f32_16x16x32_bf16 v[140:143], v[68:71], v[188:191], v[140:143]
    s_and_b32 s8, s4, 7
    s_lshl_b32 s8, s8, 8
    v_mfma_f32_16x16x32_bf16 v[140:143], v[72:75], v[204:207], v[140:143]
    v_mul_f32_dpp v40, v37, v128 row_newbcast:0 row_mask:0xf bank_mask:0xf
    v_fmac_f32_dpp v40, v37, v129 row_newbcast:1 row_mask:0xf bank_mask:0xf
    v_fmac_f32_dpp v40, v37, v130 row_newbcast:2 row_mask:0xf bank_mask:0xf
    v_fmac_f32_dpp v40, v37, v131 row_newbcast:3 row_mask:0xf bank_mask:0xf
    v_mfma_f32_16x16x32_bf16 v[140:143], v[76:79], v[220:223], v[140:143]
    v_mul_f32_dpp v41, v37, v132 row_newbcast:0 row_mask:0xf bank_mask:0xf
    v_fmac_f32_dpp v41, v37, v133 row_newbcast:1 row_mask:0xf bank_mask:0xf
    v_fmac_f32_dpp v41, v37, v134 row_newbcast:2 row_mask:0xf bank_mask:0xf
    v_fmac_f32_dpp v41, v37, v135 row_newbcast:3 row_mask:0xf bank_mask:0xf
    v_mul_f32_dpp v42, v37, v136 row_newbcast:0 row_mask:0xf bank_mask:0xf
    v_fmac_f32_dpp v42, v37, v137 row_newbcast:1 row_mask:0xf bank_mask:0xf
    v_fmac_f32_dpp v42, v37, v138 row_newbcast:2 row_mask:0xf bank_mask:0xf
    v_fmac_f32_dpp v42, v37, v139 row_newbcast:3 row_mask:0xf bank_mask:0xf
    v_mul_f32_dpp v43, v37, v140 row_newbcast:0 row_mask:0xf bank_mask:0xf
    v_fmac_f32_dpp v43, v37, v141 row_newbcast:1 row_mask:0xf bank_mask:0xf
    v_fmac_f32_dpp v43, v37, v142 row_newbcast:2 row_mask:0xf bank_mask:0xf
    v_fmac_f32_dpp v43, v37, v143 row_newbcast:3 row_mask:0xf bank_mask:0xf
    ds_write_b128 v30, v[40:43] offset:0
    s_mov_b32 exec_lo, 0x1
    s_mov_b32 exec_hi, 0x0
    ds_add_rtn_u32 v39, v45, v39 offset:14992
    s_mov_b64 exec, -1
    ds_read_b128 v[64:67], v6 offset:0
    ds_read_b128 v[68:71], v6 offset:1024
    ds_read_b128 v[72:75], v6 offset:2048
    ds_read_b128 v[76:79], v6 offset:3072
    ds_read_b128 v[80:83], v6 offset:4096
    ds_read_b128 v[84:87], v6 offset:5120
    ds_read_b128 v[88:91], v6 offset:6144
    ds_read_b128 v[92:95], v6 offset:7168
    s_add_u32 s7, s7, s8
    s_add_u32 s8, s7, 0x20000
    s_waitcnt lgkmcnt(8)
    v_readfirstlane_b32 s7, v39
    s_nop 0
    s_cmp_lg_u32 s7, 7
    s_cbranch_scc1 L_fin_44
    s_waitcnt lgkmcnt(6)
    v_add_f32 v64, v64, v68
    v_add_f32 v65, v65, v69
    v_add_f32 v66, v66, v70
    v_add_f32 v67, v67, v71
    s_waitcnt lgkmcnt(4)
    v_add_f32 v72, v72, v76
    v_add_f32 v73, v73, v77
    v_add_f32 v74, v74, v78
    v_add_f32 v75, v75, v79
    s_waitcnt lgkmcnt(2)
    v_add_f32 v80, v80, v84
    v_add_f32 v81, v81, v85
    v_add_f32 v82, v82, v86
    v_add_f32 v83, v83, v87
    v_add_f32 v64, v64, v72
    v_add_f32 v65, v65, v73
    v_add_f32 v66, v66, v74
    v_add_f32 v67, v67, v75
    s_waitcnt lgkmcnt(0)
    v_add_f32 v88, v88, v92
    v_add_f32 v89, v89, v93
    v_add_f32 v90, v90, v94
    v_add_f32 v91, v91, v95
    v_add_f32 v80, v80, v88
    v_add_f32 v81, v81, v89
    v_add_f32 v82, v82, v90
    v_add_f32 v83, v83, v91
    v_add_f32 v64, v64, v80
    v_add_f32 v65, v65, v81
    v_add_f32 v66, v66, v82
    v_add_f32 v67, v67, v83
    v_mov_b32 v32, v64
    v_mov_b32 v33, v65
    v_mov_b32 v34, v66
    v_mov_b32 v35, v67
    s_nop 0
    v_permlane16_swap_b32 v64, v32
    v_permlane16_swap_b32 v65, v33
    v_permlane16_swap_b32 v66, v34
    v_permlane16_swap_b32 v67, v35
    s_nop 0
    v_add_f32 v64, v64, v32
    v_add_f32 v65, v65, v33
    v_add_f32 v66, v66, v34
    v_add_f32 v67, v67, v35
    v_min_u32 v64, -2, v64
    v_min_u32 v65, -2, v65
    v_min_u32 v66, -2, v66
    v_min_u32 v67, -2, v67
    s_mov_b32 exec_lo, 0xffff
    s_mov_b32 exec_hi, 0xffff
    buffer_store_dwordx4 v[64:67], v26, s[52:55], s8 offen sc1
    s_mov_b64 exec, -1
    s_branch L_fin_44
L_next_45:
    s_cmp_eq_u32 s14, 3
    s_cbranch_scc1 L_roleF2_43
    v_lshrrev_b32 v26, 2, v2
    v_lshlrev_b32 v26, 12, v26
    v_and_b32 v27, 1, v2
    v_lshl_add_u32 v26, v27, 11, v26
    v_bfe_u32 v28, v2, 1, 1
    v_lshl_add_u32 v26, v28, 7, v26
    v_lshl_add_u32 v26, v3, 5, v26
    s_lshl_b32 s7, s3, 8
    s_add_u32 s7, s7, 0x20000
    v_and_b32 v30, 31, v1
    v_lshlrev_b32 v30, 5, v30
    s_lshl_b32 s11, s3, 2
    v_add_u32 v30, s11, v30
    v_lshlrev_b32 v31, 6, v27
    s_lshl_b32 s11, s3, 3
    v_add_u32 v31, s11, v31
    v_lshlrev_b32 v29, 5, v1
    s_lshl_b32 s11, s3, 11
    v_add_u32 v29, s11, v29
    v_lshrrev_b32 v47, 1, v3
    v_lshlrev_b32 v46, 5, v2
    v_lshl_add_u32 v46, v47, 9, v46
    s_lshl_b32 s11, s3, 10
    v_add_u32 v46, s11, v46
    v_mov_b32 v48, 0x3f803f80
    v_mov_b32 v49, 0x3f803f80
    v_mov_b32 v50, 0x3f803f80
    v_mov_b32 v51, 0x3f803f80
    v_lshl_add_u32 v47, v47, 4, v2
    s_lshl_b32 s11, s3, 5
    v_add_u32 v47, s11, v47
    v_cmp_gt_u32 vcc, 88, v47
    s_mul_i32 s11, s15, 88
    v_add_u32 v47, s11, v47
    v_lshrrev_b32 v27, 5, v47
    v_and_b32 v28, 30, v47
    v_lshlrev_b32 v28, 1, v28
    v_lshl_add_u32 v27, v27, 7, v28
    v_and_b32 v28, 1, v3
    v_lshl_add_u32 v27, v28, 6, v27
    v_mov_b32 v45, 0x10000000
    v_cndmask_b32 v27, v45, v27, vcc
    v_cmp_gt_u32 vcc, 1376, v47
    v_lshlrev_b32 v28, 6, v28
    s_nop 0
    v_cndmask_b32 v47, v45, v27, vcc
L_f1p_48:
    buffer_load_dwordx4 v[112:115], v26, s[52:55], s7 offen sc1
    buffer_load_dwordx4 v[116:119], v26, s[52:55], s7 offen offset:16 sc1
    s_mov_b64 exec, -1
    s_sub_u32 s13, s13, 1
    s_waitcnt vmcnt(0)
    v_max3_u32 v32, v112, v113, v114
    v_max3_u32 v33, v117, v118, v119
    v_max3_u32 v32, v32, v115, v116
    v_max_u32 v32, v32, v33
    v_cmp_eq_u32 vcc, -1, v32
    s_cbranch_vccz L_f1ok_49
    s_mov_b64 exec, vcc
    s_cmp_gt_i32 s13, 0
    s_cbranch_scc1 L_f1p_48
    s_mov_b64 exec, -1
L_f1ok_49:
    ds_read_b128 v[144:147], v46 offset:15360
    ds_read_b128 v[148:151], v46 offset:15376
    v_add_f32_dpp v64, v112, v112 row_ror:4 row_mask:0xf bank_mask:0xf
    v_add_f32_dpp v65, v113, v113 row_ror:4 row_mask:0xf bank_mask:0xf
    v_add_f32_dpp v66, v114, v114 row_ror:4 row_mask:0xf bank_mask:0xf
    v_add_f32_dpp v67, v115, v115 row_ror:4 row_mask:0xf bank_mask:0xf
    v_add_f32_dpp v68, v116, v116 row_ror:4 row_mask:0xf bank_mask:0xf
    v_add_f32_dpp v69, v117, v117 row_ror:4 row_mask:0xf bank_mask:0xf
    v_add_f32_dpp v70, v118, v118 row_ror:4 row_mask:0xf bank_mask:0xf
    v_add_f32_dpp v71, v119, v119 row_ror:4 row_mask:0xf bank_mask:0xf
    v_add_f32_dpp v64, v64, v64 row_ror:8 row_mask:0xf bank_mask:0xf
    v_add_f32_dpp v65, v65, v65 row_ror:8 row_mask:0xf bank_mask:0xf
    v_add_f32_dpp v66, v66, v66 row_ror:8 row_mask:0xf bank_mask:0xf
    v_add_f32_dpp v67, v67, v67 row_ror:8 row_mask:0xf bank_mask:0xf
    v_add_f32_dpp v68, v68, v68 row_ror:8 row_mask:0xf bank_mask:0xf
    v_add_f32_dpp v69, v69, v69 row_ror:8 row_mask:0xf bank_mask:0xf
    v_add_f32_dpp v70, v70, v70 row_ror:8 row_mask:0xf bank_mask:0xf
    v_add_f32_dpp v71, v71, v71 row_ror:8 row_mask:0xf bank_mask:0xf
    v_cvt_pk_bf16_f32 v36, v64, v65
    v_cvt_pk_bf16_f32 v37, v66, v67
    v_cvt_pk_bf16_f32 v38, v68, v69
    v_cvt_pk_bf16_f32 v39, v70, v71
    v_lshlrev_b32 v64, 16, v36
    v_and_b32 v65, 0xffff0000, v36
    v_lshlrev_b32 v66, 16, v37
    v_and_b32 v67, 0xffff0000, v37
    v_lshlrev_b32 v68, 16, v38
    v_and_b32 v69, 0xffff0000, v38
    v_lshlrev_b32 v70, 16, v39
    v_and_b32 v71, 0xffff0000, v39
    v_add_f32 v64, v64, v120
    v_add_f32 v65, v65, v121
    v_add_f32 v66, v66, v122
    v_add_f32 v67, v67, v123
    v_add_f32 v68, v68, v124
    v_add_f32 v69, v69, v125
    v_add_f32 v70, v70, v126
    v_add_f32 v71, v71, v127
    v_cvt_pk_bf16_f32 v32, v64, v65
    v_cvt_pk_bf16_f32 v33, v66, v67
    v_cvt_pk_bf16_f32 v34, v68, v69
    v_cvt_pk_bf16_f32 v35, v70, v71
    s_nop 1
    v_mfma_f32_16x16x32_bf16 v[208:211], v[32:35], v[48:51], 0
    v_mfma_f32_16x16x32_bf16 v[212:215], v[32:35], v[32:35], 0
    s_waitcnt lgkmcnt(0)
    v_add_f32 v144, v144, v148
    v_add_f32 v145, v145, v149
    v_add_f32 v146, v146, v150
    v_add_f32 v147, v147, v151
    v_add_f32 v144, v144, v146
    v_add_f32 v145, v145, v147
    v_add_f32 v144, v144, v145
    v_mfma_f32_16x16x32_bf16 v[160:163], v[32:35], v[224:227], 0
    v_mfma_f32_16x16x32_bf16 v[184:187], v[32:35], v[248:251], 0
    v_mfma_f32_16x16x32_bf16 v[164:167], v[32:35], v[228:231], 0
    v_mfma_f32_16x16x32_bf16 v[188:191], v[32:35], v[252:255], 0
    v_mfma_f32_16x16x32_bf16 v[168:171], v[32:35], v[232:235], 0
    v_mfma_f32_16x16x32_bf16 v[192:195], v[32:35], v[96:99], 0
    v_mfma_f32_16x16x32_bf16 v[172:175], v[32:35], v[236:239], 0
    v_mfma_f32_16x16x32_bf16 v[196:199], v[32:35], v[100:103], 0
    v_mfma_f32_16x16x32_bf16 v[176:179], v[32:35], v[240:243], 0
    v_mfma_f32_16x16x32_bf16 v[200:203], v[32:35], v[104:107], 0
    v_add_f32 v42, v208, v210
    v_add_f32 v43, v209, v211
    v_cndmask_b32 v44, v212, v213, s[70:71]
    v_cndmask_b32 v45, v214, v215, s[70:71]
    v_cndmask_b32 v40, v42, v43, s[70:71]
    s_nop 0
    v_add_f32_dpp v41, v45, v44 quad_perm:[2,3,0,1] row_mask:0xf bank_mask:0xf
    s_mov_b32 exec_lo, 3
    s_mov_b32 exec_hi, 0
    ds_write_b64 v31, v[40:41] offset:15040
    s_mov_b64 exec, -1
    v_mfma_f32_16x16x32_bf16 v[180:183], v[32:35], v[244:247], 0
    v_mfma_f32_16x16x32_bf16 v[204:207], v[32:35], v[108:111], 0
    v_add_f32 v44, v160, v186
    v_add_f32 v45, v161, v187
    v_cndmask_b32 v76, v44, v45, s[74:75]
    ds_write_b32 v30, v76 offset:8192
    v_add_f32 v44, v164, v190
    v_add_f32 v45, v165, v191
    v_cndmask_b32 v77, v44, v45, s[74:75]
    ds_write_b32 v30, v77 offset:9216
    v_add_f32 v44, v168, v194
    v_add_f32 v45, v169, v195
    v_cndmask_b32 v78, v44, v45, s[74:75]
    ds_write_b32 v30, v78 offset:10240
    v_add_f32 v44, v172, v198
    v_add_f32 v45, v173, v199
    v_cndmask_b32 v79, v44, v45, s[74:75]
    ds_write_b32 v30, v79 offset:11264
    v_add_f32 v44, v176, v202
    v_add_f32 v45, v177, v203
    v_cndmask_b32 v80, v44, v45, s[74:75]
    ds_write_b32 v30, v80 offset:12288
    v_add_f32 v44, v180, v206
    v_add_f32 v45, v181, v207
    v_cndmask_b32 v81, v44, v45, s[74:75]
    ds_write_b32 v30, v81 offset:13312
    s_waitcnt lgkmcnt(0)
    s_barrier
    s_cmp_ge_u32 s3, 3
    s_cbranch_scc1 L_fin_44
    ds_read_b128 v[76:79], v28 offset:15040
    ds_read_b128 v[80:83], v28 offset:15056
    ds_read_b128 v[84:87], v28 offset:15072
    ds_read_b128 v[88:91], v28 offset:15088
    ds_read_b128 v[64:67], v29 offset:8192
    ds_read_b128 v[68:71], v29 offset:8208
    s_mov_b32 s7, 0x2a000
    s_mov_b32 s8, 0x28000
    s_waitcnt lgkmcnt(2)
    v_add_f32 v76, v76, v84
    v_add_f32 v77, v77, v85
    v_add_f32 v78, v78, v86
    v_add_f32 v79, v79, v87
    v_add_f32 v80, v80, v88
    v_add_f32 v81, v81, v89
    v_add_f32 v82, v82, v90
    v_add_f32 v83, v83, v91
    v_add_f32 v76, v76, v80
    v_add_f32 v77, v77, v81
    v_add_f32 v78, v78, v82
    v_add_f32 v79, v79, v83
    v_add_f32 v76, v76, v78
    v_add_f32 v77, v77, v79
    v_mul_f32 v31, 0x3b000000, v76
    v_mul_f32 v32, 0x3b000000, v77
    v_fma_f32 v32, -v31, v31, v32
    v_max_f32 v32, 0, v32
    s_waitcnt lgkmcnt(0)
    v_cvt_pk_bf16_f32 v32, v32, v32
    v_add_f32 v64, v64, v68
    v_and_b32 v32, 0xffff0000, v32
    v_add_f32 v65, v65, v69
    v_add_f32 v32, 0x3727c5ac, v32
    v_add_f32 v66, v66, v70
    v_cvt_pk_bf16_f32 v32, v32, v32
    v_add_f32 v67, v67, v71
    v_and_b32 v32, 0xffff0000, v32
    v_cvt_pk_bf16_f32 v31, v31, v31
    v_sqrt_f32 v32, v32
    v_add_f32 v64, v64, v66
    v_add_f32 v65, v65, v67
    v_cvt_pk_bf16_f32 v32, v32, v32
    v_and_b32 v31, 0xffff0000, v31
    v_and_b32 v32, 0xffff0000, v32
    v_add_f32 v64, v64, v65
    v_rcp_f32 v33, v32
    v_fma_f32 v64, -v31, v144, v64
    v_mul_f32 v34, v64, v33
    v_fma_f32 v35, -v34, v32, v64
    v_fmac_f32 v34, v35, v33
    v_cvt_pk_bf16_f32 v34, v34, v34
    v_and_b32 v34, 0xffff0000, v34
    v_add_f32 v34, v34, v62
    v_cvt_pk_bf16_f32 v34, v34, v34
    v_and_b32 v34, 0xffff0000, v34
    v_mul_f32 v35, v34, v34
    v_mov_b32 v36, 0xc0135761
    v_fmac_f32 v36, 0xbdd2d3e8, v35
    v_mul_f32 v35, v36, v34
    v_exp_f32 v35, v35
    s_nop 0
    v_add_f32 v35, 1.0, v35
    v_rcp_f32 v35, v35
    s_nop 0
    v_mul_f32 v34, v34, v35
    s_nop 1
    v_mov_b32_dpp v36, v34 quad_perm:[1,1,3,3] row_mask:0xf bank_mask:0xf
    v_cvt_pk_bf16_f32 v35, v34, v36
    v_min_u32 v35, -2, v35
    s_mov_b32 exec_lo, 0x55555555
    s_mov_b32 exec_hi, 0x55555555
    buffer_store_dword v35, v47, s[52:55], s7 offen
    buffer_store_dword v35, v47, s[52:55], s8 offen sc1
    s_mov_b64 exec, -1
    s_branch L_fin_44
L_roleF2_43:
    s_mov_b32 s64, s36
    s_and_b32 s65, s37, 0xffff
    s_mov_b32 s66, 0x800
    s_mov_b32 s67, 0x20000
    v_lshlrev_b32 v26, 2, v2
    s_mov_b32 s7, 0x2b800
    buffer_load_dword v27, v26, s[52:55], s7 offen sc1
    s_getreg_b32 s7, hwreg(HW_REG_XCC_ID)
    s_and_b32 s7, s7, 15
    s_waitcnt vmcnt(0)
    v_cmp_ne_u32 vcc, s7, v27
    s_cmp_eq_u64 vcc, 0
    s_cselect_b32 s94, 31, 0
    v_and_b32 v26, 1, v2
    v_lshlrev_b32 v26, 6, v26
    v_lshl_add_u32 v26, v3, 4, v26
    s_lshl_b32 s7, s3, 7
    v_add_u32 v26, s7, v26
    v_add_u32 v27, 0x1000, v26
    s_cmp_lt_u32 s3, 3
    s_cselect_b32 s7, 0, 1
    s_lshl_b32 s7, s7, 28
    s_add_u32 s7, s7, 0x1400
    v_add_u32 v28, s7, v26
    v_and_b32 v29, 31, v1
    v_lshlrev_b32 v29, 5, v29
    s_lshl_b32 s11, s3, 2
    v_add_u32 v30, s11, v29
    v_lshlrev_b32 v29, 5, v1
    s_cmp_lg_u32 s3, 0
    s_cbranch_scc1 L_noh_50
    v_and_b32 v31, 1, v3
    v_lshlrev_b32 v31, 11, v31
    v_lshl_add_u32 v31, v2, 4, v31
    v_lshrrev_b32 v32, 1, v3
    v_lshl_add_u32 v31, v32, 2, v31
    v_add_u32 v33, 0x1000, v31
    v_add_u32 v34, 0x2000, v31
    v_add_u32 v35, 0x3000, v31
    s_lshr_b32 s7, s15, 1
    s_lshl_b32 s7, s7, 8
    s_and_b32 s8, s15, 1
    s_lshl_b32 s8, s8, 3
    s_add_u32 s7, s7, s8
    s_add_u32 s7, s7, 0x20000
L_hp_51:
    buffer_load_dword v112, v31, s[52:55], s7 offen sc1
    buffer_load_dword v113, v33, s[52:55], s7 offen sc1
    buffer_load_dword v114, v34, s[52:55], s7 offen sc1
    buffer_load_dword v115, v35, s[52:55], s7 offen sc1
    s_mov_b64 exec, -1
    s_sub_u32 s13, s13, 1
    s_waitcnt vmcnt(0)
    v_max3_u32 v32, v112, v113, v114
    v_max_u32 v32, v32, v115
    v_cmp_eq_u32 vcc, -1, v32
    s_cbranch_vccz L_hok_52
    s_mov_b64 exec, vcc
    s_cmp_gt_i32 s13, 0
    s_cbranch_scc1 L_hp_51
    s_mov_b64 exec, -1
L_hok_52:
    v_add_f32 v112, v112, v115
    v_add_f32 v114, v114, v113
    v_add_f32 v112, v112, v114
    v_cvt_pk_bf16_f32 v112, v112, v112
    v_and_b32 v112, 0xffff0000, v112
    v_add_f32 v57, v112, v63
    v_cvt_pk_bf16_f32 v57, v57, v57
    v_and_b32 v57, 0xffff0000, v57
    v_lshlrev_b32 v31, 2, v1
    ds_write_b32 v31, v57 offset:0
L_noh_50:
    v_lshlrev_b32 v31, 2, v1
    v_mov_b32 v39, 1
    v_mov_b32 v45, 0
    s_mov_b32 s7, 0x2a000
    s_mov_b32 s42, s7
L_f2p_53:
    buffer_load_dwordx4 v[64:67], v26, s[52:55], s7 offen offset:0 sc1
    buffer_load_dwordx4 v[68:71], v26, s[52:55], s7 offen offset:1024 sc1
    buffer_load_dwordx4 v[72:75], v26, s[52:55], s7 offen offset:2048 sc1
    buffer_load_dwordx4 v[76:79], v26, s[52:55], s7 offen offset:3072 sc1
    buffer_load_dwordx4 v[80:83], v27, s[52:55], s7 offen offset:0 sc1
    buffer_load_dwordx4 v[84:87], v28, s[52:55], s7 offen offset:0 sc1
    s_and_b32 s10, s13, s94
    s_cselect_b32 s10, 0, 0x2000
    s_xor_b32 s7, s42, s10
    s_mov_b64 exec, -1
    s_sub_u32 s13, s13, 1
    s_waitcnt vmcnt(0)
    v_mfma_f32_16x16x32_bf16 v[128:131], v[64:67], v[224:227], 0
    v_max3_u32 v32, v64, v65, v66
    v_max3_u32 v33, v77, v78, v79
    v_mfma_f32_16x16x32_bf16 v[132:135], v[64:67], v[228:231], 0
    v_max3_u32 v32, v32, v67, v68
    v_max3_u32 v33, v33, v80, v81
    v_mfma_f32_16x16x32_bf16 v[128:131], v[68:71], v[232:235], v[128:131]
    v_max3_u32 v32, v32, v69, v70
    v_max3_u32 v33, v33, v82, v83
    v_mfma_f32_16x16x32_bf16 v[132:135], v[68:71], v[236:239], v[132:135]
    v_max3_u32 v32, v32, v71, v72
    v_max3_u32 v33, v33, v84, v85
    v_max3_u32 v32, v32, v73, v74
    v_max3_u32 v33, v33, v86, v87
    v_max3_u32 v32, v32, v75, v76
    v_max_u32 v32, v32, v33
    v_cmp_eq_u32 vcc, -1, v32
    s_cbranch_vccz L_f2ok_54
    s_mov_b64 exec, vcc
    s_cmp_gt_i32 s13, 0
    s_cbranch_scc1 L_f2p_53
    s_mov_b64 exec, -1
L_f2ok_54:
    v_mfma_f32_16x16x32_bf16 v[128:131], v[72:75], v[240:243], v[128:131]
    v_mfma_f32_16x16x32_bf16 v[132:135], v[72:75], v[244:247], v[132:135]
    v_mfma_f32_16x16x32_bf16 v[128:131], v[76:79], v[248:251], v[128:131]
    v_mfma_f32_16x16x32_bf16 v[132:135], v[76:79], v[252:255], v[132:135]
    v_mfma_f32_16x16x32_bf16 v[128:131], v[80:83], v[96:99], v[128:131]
    v_mfma_f32_16x16x32_bf16 v[132:135], v[80:83], v[100:103], v[132:135]
    v_mfma_f32_16x16x32_bf16 v[128:131], v[84:87], v[104:107], v[128:131]
    v_mfma_f32_16x16x32_bf16 v[132:135], v[84:87], v[108:111], v[132:135]
    v_and_b32 v26, 1, v3
    v_lshlrev_b32 v26, 10, v26
    v_lshl_add_u32 v26, v2, 1, v26
    v_lshrrev_b32 v27, 1, v3
    v_lshl_add_u32 v26, v27, 5, v26
    s_lshl_b32 s7, s15, 6
    s_nop 0
    v_cndmask_b32 v36, v128, v129, s[74:75]
    ds_write_b32 v30, v36 offset:8192
    v_cndmask_b32 v37, v132, v133, s[74:75]
    ds_write_b32 v30, v37 offset:9216
    s_mov_b32 exec_lo, 0x1
    s_mov_b32 exec_hi, 0x0
    ds_add_rtn_u32 v39, v45, v39 offset:14992
    s_mov_b64 exec, -1
    ds_read_b128 v[64:67], v29 offset:8192
    ds_read_b128 v[68:71], v29 offset:8208
    ds_read_b32 v57, v31 offset:0
    s_or_b32 s8, s15, s3
    s_cmp_lg_u32 s8, 0
    s_cbranch_scc1 L_noep_55
    v_mov_b32 v36, s96
    s_mov_b32 s8, 0x44000
    buffer_store_dword v36, v7, s[52:55], s8 offen
L_noep_55:
    s_waitcnt lgkmcnt(3)
    v_readfirstlane_b32 s8, v39
    s_nop 0
    s_cmp_lg_u32 s8, 7
    s_cbranch_scc1 L_fin_44
    s_waitcnt lgkmcnt(0)
    v_add_f32 v64, v64, v68
    v_add_f32 v65, v65, v69
    v_add_f32 v66, v66, v70
    v_add_f32 v67, v67, v71
    v_add_f32 v64, v64, v66
    v_add_f32 v65, v65, v67
    v_add_f32 v64, v64, v65
    v_cvt_pk_bf16_f32 v64, v64, v64
    v_and_b32 v64, 0xffff0000, v64
    v_add_f32 v64, v64, v62
    v_cvt_pk_bf16_f32 v64, v64, v64
    v_and_b32 v64, 0xffff0000, v64
    v_add_f32 v64, v64, v57
    s_nop 1
    v_mov_b32_dpp v36, v64 quad_perm:[1,1,3,3] row_mask:0xf bank_mask:0xf
    v_cvt_pk_bf16_f32 v35, v64, v36
    s_mov_b32 exec_lo, 0x55555555
    s_mov_b32 exec_hi, 0x55555555
    buffer_store_dword v35, v26, s[64:67], s7 offen
    s_mov_b64 exec, -1
L_fin_44:
L_end:
    s_endpgm
L_combine:
    v_lshl_add_u32 v31, v3, 3, v26
    v_lshlrev_b32 v31, 3, v31
    s_xor_b32 s8, s94, s4
    s_and_b32 s8, s8, 1
    s_lshl_b32 s8, s8, 3
    s_add_u32 s8, s8, s5
    s_lshl_b32 s7, s4, 4
    s_add_u32 s8, s8, s7
    s_lshl_b32 s7, s8, 8
    s_lshl_b32 s8, s8, 7
    s_add_u32 s8, s8, 0x30000
    v_add_u32 v31, s7, v31
    v_cmp_eq_u32 vcc, 8, v1
    v_mov_b32 v44, s8
    s_nop 0
    v_cndmask_b32 v31, v31, v44, vcc
    s_waitcnt lgkmcnt(4)
    v_max3_f32 v32, v80, v82, v84
    v_max3_f32 v34, v86, v88, v90
    v_max3_f32 v32, v32, v92, v94
    v_max_f32 v32, v32, v34
    v_sub_f32 v34, v80, v32
    v_sub_f32 v35, v82, v32
    v_sub_f32 v36, v84, v32
    v_sub_f32 v37, v86, v32
    v_mul_f32 v34, s69, v34
    v_mul_f32 v35, s69, v35
    v_mul_f32 v36, s69, v36
    v_mul_f32 v37, s69, v37
    v_exp_f32 v34, v34
    v_exp_f32 v35, v35
    v_exp_f32 v36, v36
    v_exp_f32 v37, v37
    s_waitcnt lgkmcnt(0)
    v_mul_f32 v33, v34, v81
    v_mul_f32 v38, v34, v64
    v_mul_f32 v39, v34, v65
    v_mul_f32 v42, v34, v66
    v_mul_f32 v43, v34, v67
    v_fmac_f32 v33, v35, v83
    v_fmac_f32 v38, v35, v68
    v_fmac_f32 v39, v35, v69
    v_fmac_f32 v42, v35, v70
    v_fmac_f32 v43, v35, v71
    v_fmac_f32 v33, v36, v85
    v_fmac_f32 v38, v36, v72
    v_fmac_f32 v39, v36, v73
    v_fmac_f32 v42, v36, v74
    v_fmac_f32 v43, v36, v75
    v_fmac_f32 v33, v37, v87
    v_fmac_f32 v38, v37, v76
    v_fmac_f32 v39, v37, v77
    v_fmac_f32 v42, v37, v78
    v_fmac_f32 v43, v37, v79
    v_add_f32_dpp v33, v33, v33 row_ror:8 row_mask:0xf bank_mask:0xf
    s_nop 0
    v_add_f32_dpp v38, v38, v38 row_ror:8 row_mask:0xf bank_mask:0xf
    v_add_f32_dpp v39, v39, v39 row_ror:8 row_mask:0xf bank_mask:0xf
    v_add_f32_dpp v42, v42, v42 row_ror:8 row_mask:0xf bank_mask:0xf
    v_add_f32_dpp v43, v43, v43 row_ror:8 row_mask:0xf bank_mask:0xf
    v_cvt_pk_bf16_f32 v44, v38, v39
    v_cvt_pk_bf16_f32 v45, v42, v43
    v_cndmask_b32 v44, v44, v32, vcc
    v_cndmask_b32 v45, v45, v33, vcc
    v_min_u32 v44, -2, v44
    v_min_u32 v45, -2, v45
    s_mov_b32 exec_lo, 0xff01ff
    s_mov_b32 exec_hi, 0xff00ff
    buffer_store_dwordx2 v[44:45], v31, s[52:55], 0 offen sc1
    s_mov_b64 exec, -1
    s_setpc_b64 s[72:73]
L_prep:
    s_setprio 2
    v_bfe_u32 v29, v1, 2, 2
    v_and_b32 v30, 3, v1
    s_mul_i32 s42, s3, 13312
    v_add_u32 v28, s42, v6
    v_lshrrev_b32 v32, 3, v1
    v_and_b32 v33, 7, v1
    v_lshlrev_b32 v33, 4, v33
    s_cmp_lg_u32 s14, 1
    s_cbranch_scc1 L_b1_58
    s_mov_b32 s60, s24
    s_and_b32 s61, s25, 0xffff
    s_mov_b32 s62, 0x400000
    s_mov_b32 s63, 0x20000
    v_lshl_add_u32 v34, v32, 10, v33
    s_and_b32 s7, s4, 24
    s_add_u32 s7, s7, s3
    s_lshl_b32 s7, s7, 17
    s_and_b32 s8, s4, 7
    s_lshl_b32 s8, s8, 7
    s_add_u32 s7, s7, s8
    buffer_load_dwordx4 v[160:163], v34, s[60:63], s7 offen nt
    s_add_u32 s7, s7, 0x2000
    buffer_load_dwordx4 v[164:167], v34, s[60:63], s7 offen nt
    s_add_u32 s7, s7, 0x2000
    buffer_load_dwordx4 v[168:171], v34, s[60:63], s7 offen nt
    s_add_u32 s7, s7, 0x2000
    buffer_load_dwordx4 v[172:175], v34, s[60:63], s7 offen nt
    s_add_u32 s7, s7, 0x2000
    buffer_load_dwordx4 v[176:179], v34, s[60:63], s7 offen nt
    s_add_u32 s7, s7, 0x2000
    buffer_load_dwordx4 v[180:183], v34, s[60:63], s7 offen nt
    s_add_u32 s7, s7, 0x2000
    buffer_load_dwordx4 v[184:187], v34, s[60:63], s7 offen nt
    s_add_u32 s7, s7, 0x2000
    buffer_load_dwordx4 v[188:191], v34, s[60:63], s7 offen nt
    s_add_u32 s7, s7, 0x2000
    buffer_load_dwordx4 v[192:195], v34, s[60:63], s7 offen nt
    s_add_u32 s7, s7, 0x2000
    buffer_load_dwordx4 v[196:199], v34, s[60:63], s7 offen nt
    s_add_u32 s7, s7, 0x2000
    buffer_load_dwordx4 v[200:203], v34, s[60:63], s7 offen nt
    s_add_u32 s7, s7, 0x2000
    buffer_load_dwordx4 v[204:207], v34, s[60:63], s7 offen nt
    s_add_u32 s7, s7, 0x2000
    buffer_load_dwordx4 v[208:211], v34, s[60:63], s7 offen nt
    s_add_u32 s7, s7, 0x2000
    buffer_load_dwordx4 v[212:215], v34, s[60:63], s7 offen nt
    s_add_u32 s7, s7, 0x2000
    buffer_load_dwordx4 v[216:219], v34, s[60:63], s7 offen nt
    s_add_u32 s7, s7, 0x2000
    buffer_load_dwordx4 v[220:223], v34, s[60:63], s7 offen nt
    v_lshlrev_b32 v31, 1, v3
    v_lshl_add_u32 v31, v29, 3, v31
    v_lshlrev_b32 v31, 7, v31
    v_lshl_add_u32 v31, v30, 3, v31
    v_add_u32 v31, s42, v31
    s_waitcnt vmcnt(8)
    ds_write_b128 v28, v[160:163] offset:34816
    ds_write_b128 v28, v[164:167] offset:35840
    ds_write_b128 v28, v[168:171] offset:36864
    ds_write_b128 v28, v[172:175] offset:37888
    ds_write_b128 v28, v[176:179] offset:38912
    ds_write_b128 v28, v[180:183] offset:39936
    ds_write_b128 v28, v[184:187] offset:40960
    ds_write_b128 v28, v[188:191] offset:41984
    s_waitcnt lgkmcnt(0)
    ds_read_b64_tr_b16 v[160:161], v31 offset:34816
    ds_read_b64_tr_b16 v[162:163], v31 offset:34944
    ds_read_b64_tr_b16 v[164:165], v31 offset:34848
    ds_read_b64_tr_b16 v[166:167], v31 offset:34976
    ds_read_b64_tr_b16 v[168:169], v31 offset:34880
    ds_read_b64_tr_b16 v[170:171], v31 offset:35008
    ds_read_b64_tr_b16 v[172:173], v31 offset:34912
    ds_read_b64_tr_b16 v[174:175], v31 offset:35040
    ds_read_b64_tr_b16 v[176:177], v31 offset:38912
    ds_read_b64_tr_b16 v[178:179], v31 offset:39040
    ds_read_b64_tr_b16 v[180:181], v31 offset:38944
    ds_read_b64_tr_b16 v[182:183], v31 offset:39072
    ds_read_b64_tr_b16 v[184:185], v31 offset:38976
    ds_read_b64_tr_b16 v[186:187], v31 offset:39104
    ds_read_b64_tr_b16 v[188:189], v31 offset:39008
    ds_read_b64_tr_b16 v[190:191], v31 offset:39136
    s_waitcnt lgkmcnt(0)
    s_waitcnt vmcnt(0)
    ds_write_b128 v28, v[192:195] offset:34816
    ds_write_b128 v28, v[196:199] offset:35840
    ds_write_b128 v28, v[200:203] offset:36864
    ds_write_b128 v28, v[204:207] offset:37888
    ds_write_b128 v28, v[208:211] offset:38912
    ds_write_b128 v28, v[212:215] offset:39936
    ds_write_b128 v28, v[216:219] offset:40960
    ds_write_b128 v28, v[220:223] offset:41984
    s_waitcnt lgkmcnt(0)
    ds_read_b64_tr_b16 v[192:193], v31 offset:34816
    ds_read_b64_tr_b16 v[194:195], v31 offset:34944
    ds_read_b64_tr_b16 v[196:197], v31 offset:34848
    ds_read_b64_tr_b16 v[198:199], v31 offset:34976
    ds_read_b64_tr_b16 v[200:201], v31 offset:34880
    ds_read_b64_tr_b16 v[202:203], v31 offset:35008
    ds_read_b64_tr_b16 v[204:205], v31 offset:34912
    ds_read_b64_tr_b16 v[206:207], v31 offset:35040
    ds_read_b64_tr_b16 v[208:209], v31 offset:38912
    ds_read_b64_tr_b16 v[210:211], v31 offset:39040
    ds_read_b64_tr_b16 v[212:213], v31 offset:38944
    ds_read_b64_tr_b16 v[214:215], v31 offset:39072
    ds_read_b64_tr_b16 v[216:217], v31 offset:38976
    ds_read_b64_tr_b16 v[218:219], v31 offset:39104
    ds_read_b64_tr_b16 v[220:221], v31 offset:39008
    ds_read_b64_tr_b16 v[222:223], v31 offset:39136
    s_waitcnt lgkmcnt(0)
    s_branch L_bd_57
L_b1_58:
    s_cmp_eq_u32 s14, 3
    s_cbranch_scc1 L_b2_56
    s_mov_b32 s60, s28
    s_and_b32 s61, s29, 0xffff
    s_mov_b32 s62, 0x158000
    s_mov_b32 s63, 0x20000
    v_mul_u32_u24 v32, 43, v1
    v_lshrrev_b32 v32, 9, v32
    v_mul_u32_u24 v33, 12, v32
    v_sub_u32 v33, v1, v33
    v_mul_u32_u24 v34, 2752, v32
    v_lshl_add_u32 v34, v33, 4, v34
    s_mul_i32 s7, s3, 176128
    s_mul_i32 s8, s15, 176
    s_add_u32 s7, s7, s8
    buffer_load_dwordx4 v[224:227], v34, s[60:63], s7 offen nt
    s_add_u32 s7, s7, 13760
    buffer_load_dwordx4 v[228:231], v34, s[60:63], s7 offen nt
    s_add_u32 s7, s7, 13760
    buffer_load_dwordx4 v[232:235], v34, s[60:63], s7 offen nt
    s_add_u32 s7, s7, 13760
    buffer_load_dwordx4 v[236:239], v34, s[60:63], s7 offen nt
    s_add_u32 s7, s7, 13760
    buffer_load_dwordx4 v[240:243], v34, s[60:63], s7 offen nt
    s_add_u32 s7, s7, 13760
    buffer_load_dwordx4 v[244:247], v34, s[60:63], s7 offen nt
    s_add_u32 s7, s7, 13760
    buffer_load_dwordx4 v[248:251], v34, s[60:63], s7 offen nt
    s_add_u32 s7, s7, 13760
    buffer_load_dwordx4 v[252:255], v34, s[60:63], s7 offen nt
    s_add_u32 s7, s7, 13760
    buffer_load_dwordx4 v[96:99], v34, s[60:63], s7 offen nt
    s_add_u32 s7, s7, 13760
    buffer_load_dwordx4 v[100:103], v34, s[60:63], s7 offen nt
    s_add_u32 s7, s7, 13760
    buffer_load_dwordx4 v[104:107], v34, s[60:63], s7 offen nt
    s_add_u32 s7, s7, 13760
    buffer_load_dwordx4 v[108:111], v34, s[60:63], s7 offen nt
    s_add_u32 s7, s7, 13760
    buffer_load_dwordx4 v[92:95], v34, s[60:63], s7 offen nt
    v_and_b32 v35, 1, v2
    v_lshlrev_b32 v35, 10, v35
    v_bfe_u32 v36, v2, 1, 1
    v_lshl_add_u32 v36, v36, 4, v35
    v_lshl_add_u32 v36, v3, 2, v36
    s_lshl_b32 s7, s3, 7
    buffer_load_dword v58, v36, s[56:59], s7 offen offset:0
    buffer_load_dword v59, v36, s[56:59], s7 offen offset:32
    buffer_load_dword v60, v36, s[56:59], s7 offen offset:64
    buffer_load_dword v61, v36, s[56:59], s7 offen offset:96
    s_mov_b32 s60, s30
    s_and_b32 s61, s31, 0xffff
    s_mov_b32 s62, 0xac0
    s_mov_b32 s63, 0x20000
    v_lshrrev_b32 v36, 1, v3
    v_lshlrev_b32 v35, 1, v2
    v_lshl_add_u32 v35, v36, 5, v35
    s_lshl_b32 s7, s3, 6
    s_add_u32 s7, s7, s8
    buffer_load_ushort v62, v35, s[60:63], s7 offen
    v_lshlrev_b32 v31, 1, v3
    v_lshl_add_u32 v31, v29, 4, v31
    v_mul_u32_u24 v31, 192, v31
    v_lshl_add_u32 v31, v30, 3, v31
    v_add_u32 v31, s42, v31
    s_waitcnt vmcnt(0)
    ds_write_b128 v28, v[224:227] offset:34816
    ds_write_b128 v28, v[228:231] offset:35776
    ds_write_b128 v28, v[232:235] offset:36736
    ds_write_b128 v28, v[236:239] offset:37696
    ds_write_b128 v28, v[240:243] offset:38656
    ds_write_b128 v28, v[244:247] offset:39616
    ds_write_b128 v28, v[248:251] offset:40576
    ds_write_b128 v28, v[252:255] offset:41536
    ds_write_b128 v28, v[96:99] offset:42496
    ds_write_b128 v28, v[100:103] offset:43456
    ds_write_b128 v28, v[104:107] offset:44416
    ds_write_b128 v28, v[108:111] offset:45376
    ds_write_b128 v28, v[92:95] offset:46336
    s_waitcnt lgkmcnt(0)
    ds_read_b64_tr_b16 v[224:225], v31 offset:34816
    ds_read_b64_tr_b16 v[226:227], v31 offset:35008
    ds_read_b64_tr_b16 v[228:229], v31 offset:34848
    ds_read_b64_tr_b16 v[230:231], v31 offset:35040
    ds_read_b64_tr_b16 v[232:233], v31 offset:34880
    ds_read_b64_tr_b16 v[234:235], v31 offset:35072
    ds_read_b64_tr_b16 v[236:237], v31 offset:34912
    ds_read_b64_tr_b16 v[238:239], v31 offset:35104
    ds_read_b64_tr_b16 v[240:241], v31 offset:34944
    ds_read_b64_tr_b16 v[242:243], v31 offset:35136
    ds_read_b64_tr_b16 v[244:245], v31 offset:34976
    ds_read_b64_tr_b16 v[246:247], v31 offset:35168
    ds_read_b64_tr_b16 v[248:249], v31 offset:36352
    ds_read_b64_tr_b16 v[250:251], v31 offset:36544
    ds_read_b64_tr_b16 v[252:253], v31 offset:36384
    ds_read_b64_tr_b16 v[254:255], v31 offset:36576
    ds_read_b64_tr_b16 v[96:97], v31 offset:36416
    ds_read_b64_tr_b16 v[98:99], v31 offset:36608
    ds_read_b64_tr_b16 v[100:101], v31 offset:36448
    ds_read_b64_tr_b16 v[102:103], v31 offset:36640
    ds_read_b64_tr_b16 v[104:105], v31 offset:36480
    ds_read_b64_tr_b16 v[106:107], v31 offset:36672
    ds_read_b64_tr_b16 v[108:109], v31 offset:36512
    ds_read_b64_tr_b16 v[110:111], v31 offset:36704
    v_lshlrev_b32 v120, 16, v58
    v_and_b32 v124, 0xffff0000, v58
    v_lshlrev_b32 v121, 16, v59
    v_and_b32 v125, 0xffff0000, v59
    v_lshlrev_b32 v122, 16, v60
    v_and_b32 v126, 0xffff0000, v60
    v_lshlrev_b32 v123, 16, v61
    v_and_b32 v127, 0xffff0000, v61
    v_lshlrev_b32 v62, 16, v62
    v_mov_b32 v48, 0x3f803f80
    v_mov_b32 v49, 0x3f803f80
    v_mov_b32 v50, 0x3f803f80
    v_mov_b32 v51, 0x3f803f80
    s_waitcnt lgkmcnt(0)
    s_nop 0
    v_mfma_f32_16x16x32_bf16 v[64:67], v[48:51], v[224:227], 0
    v_mfma_f32_16x16x32_bf16 v[68:71], v[48:51], v[228:231], 0
    v_mfma_f32_16x16x32_bf16 v[72:75], v[48:51], v[232:235], 0
    v_mfma_f32_16x16x32_bf16 v[76:79], v[48:51], v[236:239], 0
    v_mfma_f32_16x16x32_bf16 v[80:83], v[48:51], v[240:243], 0
    v_mfma_f32_16x16x32_bf16 v[84:87], v[48:51], v[244:247], 0
    v_mfma_f32_16x16x32_bf16 v[64:67], v[48:51], v[248:251], v[64:67]
    v_mfma_f32_16x16x32_bf16 v[68:71], v[48:51], v[252:255], v[68:71]
    v_mfma_f32_16x16x32_bf16 v[72:75], v[48:51], v[96:99], v[72:75]
    v_mfma_f32_16x16x32_bf16 v[76:79], v[48:51], v[100:103], v[76:79]
    v_mfma_f32_16x16x32_bf16 v[80:83], v[48:51], v[104:107], v[80:83]
    v_mfma_f32_16x16x32_bf16 v[84:87], v[48:51], v[108:111], v[84:87]
    s_lshl_b32 s7, s3, 2
    v_lshlrev_b32 v28, 5, v2
    v_add_u32 v28, s7, v28
    s_nop 7
    ds_write_b32 v28, v64 offset:15360
    ds_write_b32 v28, v68 offset:15872
    ds_write_b32 v28, v72 offset:16384
    ds_write_b32 v28, v76 offset:16896
    ds_write_b32 v28, v80 offset:17408
    ds_write_b32 v28, v84 offset:17920
    s_waitcnt lgkmcnt(0)
    s_branch L_bd_57
L_b2_56:
    s_mov_b32 s60, s32
    s_and_b32 s61, s33, 0xffff
    s_mov_b32 s62, 0x158000
    s_mov_b32 s63, 0x20000
    v_lshrrev_b32 v34, 2, v1
    v_lshlrev_b32 v34, 10, v34
    v_lshl_add_u32 v34, v30, 4, v34
    s_lshl_b32 s7, s3, 15
    s_lshl_b32 s8, s15, 6
    s_add_u32 s7, s7, s8
    buffer_load_dwordx4 v[224:227], v34, s[60:63], s7 offen nt
    s_add_u32 s7, s7, 0x4000
    buffer_load_dwordx4 v[228:231], v34, s[60:63], s7 offen nt
    s_add_u32 s7, s7, 0x3c000
    buffer_load_dwordx4 v[232:235], v34, s[60:63], s7 offen nt
    s_add_u32 s7, s7, 0x4000
    buffer_load_dwordx4 v[236:239], v34, s[60:63], s7 offen nt
    s_add_u32 s7, s7, 0x3c000
    buffer_load_dwordx4 v[240:243], v34, s[60:63], s7 offen nt
    s_add_u32 s7, s7, 0x4000
    buffer_load_dwordx4 v[244:247], v34, s[60:63], s7 offen nt
    s_add_u32 s7, s7, 0x3c000
    buffer_load_dwordx4 v[248:251], v34, s[60:63], s7 offen nt
    s_add_u32 s7, s7, 0x4000
    buffer_load_dwordx4 v[252:255], v34, s[60:63], s7 offen nt
    s_add_u32 s7, s7, 0x3c000
    buffer_load_dwordx4 v[96:99], v34, s[60:63], s7 offen nt
    s_add_u32 s7, s7, 0x4000
    buffer_load_dwordx4 v[100:103], v34, s[60:63], s7 offen nt
    s_add_u32 s7, s7, 0x3c000
    buffer_load_dwordx4 v[104:107], v34, s[60:63], s7 offen nt
    s_add_u32 s7, s7, 0x4000
    buffer_load_dwordx4 v[108:111], v34, s[60:63], s7 offen nt
    v_lshrrev_b32 v36, 1, v3
    v_lshlrev_b32 v35, 1, v2
    v_lshl_add_u32 v35, v36, 5, v35
    v_and_b32 v36, 1, v3
    v_lshl_add_u32 v36, v36, 10, v35
    buffer_load_ushort v63, v36, s[56:59], s8 offen
    s_mov_b32 s60, s34
    s_and_b32 s61, s35, 0xffff
    s_mov_b32 s62, 0x400
    s_mov_b32 s63, 0x20000
    buffer_load_ushort v62, v35, s[60:63], s8 offen
    v_lshl_add_u32 v31, v3, 3, v29
    v_lshlrev_b32 v31, 6, v31
    v_lshl_add_u32 v31, v30, 3, v31
    v_add_u32 v31, s42, v31
    s_waitcnt vmcnt(0)
    ds_write_b128 v28, v[224:227] offset:34816
    ds_write_b128 v28, v[228:231] offset:35840
    ds_write_b128 v28, v[232:235] offset:36864
    ds_write_b128 v28, v[236:239] offset:37888
    ds_write_b128 v28, v[240:243] offset:38912
    ds_write_b128 v28, v[244:247] offset:39936
    ds_write_b128 v28, v[248:251] offset:40960
    ds_write_b128 v28, v[252:255] offset:41984
    ds_write_b128 v28, v[96:99] offset:43008
    ds_write_b128 v28, v[100:103] offset:44032
    ds_write_b128 v28, v[104:107] offset:45056
    ds_write_b128 v28, v[108:111] offset:46080
    s_waitcnt lgkmcnt(0)
    ds_read_b64_tr_b16 v[224:225], v31 offset:34816
    ds_read_b64_tr_b16 v[226:227], v31 offset:35072
    ds_read_b64_tr_b16 v[228:229], v31 offset:34848
    ds_read_b64_tr_b16 v[230:231], v31 offset:35104
    ds_read_b64_tr_b16 v[232:233], v31 offset:36864
    ds_read_b64_tr_b16 v[234:235], v31 offset:37120
    ds_read_b64_tr_b16 v[236:237], v31 offset:36896
    ds_read_b64_tr_b16 v[238:239], v31 offset:37152
    ds_read_b64_tr_b16 v[240:241], v31 offset:38912
    ds_read_b64_tr_b16 v[242:243], v31 offset:39168
    ds_read_b64_tr_b16 v[244:245], v31 offset:38944
    ds_read_b64_tr_b16 v[246:247], v31 offset:39200
    ds_read_b64_tr_b16 v[248:249], v31 offset:40960
    ds_read_b64_tr_b16 v[250:251], v31 offset:41216
    ds_read_b64_tr_b16 v[252:253], v31 offset:40992
    ds_read_b64_tr_b16 v[254:255], v31 offset:41248
    ds_read_b64_tr_b16 v[96:97], v31 offset:43008
    ds_read_b64_tr_b16 v[98:99], v31 offset:43264
    ds_read_b64_tr_b16 v[100:101], v31 offset:43040
    ds_read_b64_tr_b16 v[102:103], v31 offset:43296
    ds_read_b64_tr_b16 v[104:105], v31 offset:45056
    ds_read_b64_tr_b16 v[106:107], v31 offset:45312
    ds_read_b64_tr_b16 v[108:109], v31 offset:45088
    ds_read_b64_tr_b16 v[110:111], v31 offset:45344
    v_lshlrev_b32 v63, 16, v63
    v_lshlrev_b32 v62, 16, v62
    s_waitcnt lgkmcnt(0)
L_bd_57:
    s_setprio 0
    s_setpc_b64 s[72:73]
L_codeend:
.section .rodata,"a"
.p2align 6
.amdhsa_kernel sequential_preLN__mha_block_cached__dense_activation_gelu__decode_kernel
  .amdhsa_next_free_vgpr 256
  .amdhsa_next_free_sgpr 102
  .amdhsa_accum_offset 256
  .amdhsa_group_segment_fixed_size 0
  .amdhsa_kernarg_size 104
  .amdhsa_user_sgpr_count 2
  .amdhsa_user_sgpr_kernarg_segment_ptr 1
  .amdhsa_system_sgpr_workgroup_id_x 1
  .amdhsa_float_denorm_mode_32 3
.end_amdhsa_kernel
```
